```python
import torch

def _softmax(x, axis=-1):
    return torch.softmax(x, dim=axis)
def _gelu(x):
    return torch.nn.functional.gelu(x, approximate="tanh")
def _silu(x):
    return torch.nn.functional.silu(x)
def _sigmoid(x):
    return torch.sigmoid(x)
def _layernorm(x, axis=-1, eps=1e-5):
    m = x.mean(dim=axis, keepdim=True)
    v = x.var(dim=axis, keepdim=True, unbiased=False)
    return (x - m) / torch.sqrt(v + eps)
def _scatter_add(tgt, idx, src, axis=0):
    return tgt.clone().index_add_(axis, idx, src)
def _segment_sum(src, seg, n):
    out = torch.zeros((n,) + src.shape[1:], dtype=src.dtype)
    return out.index_add_(0, seg, src)
def _pad(x, pw):
    flat = tuple(v for pair in reversed(pw) for v in pair)
    return torch.nn.functional.pad(x, flat)

kernel_name = 'standalone__detection_seg_fpn_lateral__vision'

def setup_inputs():

    _w = (lambda a: (lambda t: t.to(torch.bfloat16) if t.is_floating_point() else t)(torch.as_tensor(a)))
    H = W = (224 // 2) * 2
    C = 96
    k = 3
    return {
        "c_fine": _w((lambda *s: torch.randn(*s, dtype=torch.bfloat16) * 0.05)(1, H, W, C)),
        "p_coarse": _w((lambda *s: torch.randn(*s, dtype=torch.bfloat16) * 0.05)(1, H // 2, W // 2, C)),
        "w_lat": _w((lambda *s: torch.randn(*s, dtype=torch.bfloat16) * 0.05)(C, C)),
        "w_out": _w((lambda *s: torch.randn(*s, dtype=torch.bfloat16) * 0.05)(k, k, C, C)),
    }

def reference(c_fine, p_coarse, w_lat, w_out):
    B, H, W, C = c_fine.shape
    k = 3
    lat = torch.einsum("bhwc,cd->bhwd", c_fine, w_lat)
    up = (lambda x, n, axis: torch.repeat_interleave(x, n, dim=axis))((lambda x, n, axis: torch.repeat_interleave(x, n, dim=axis))(p_coarse, 2, axis=1), 2, axis=2)
    m = lat + up
    pad = k // 2
    mp = _pad(m, ((0, 0), (pad, pad), (pad, pad), (0, 0)))
    o = None
    for di in range(k):
        for dj in range(k):
            t = torch.einsum("bhwc,cd->bhwd", mp[:, di:di + H, dj:dj + W, :], w_out[di, dj])
            o = t if o is None else o + t
    return o
```

```asm
; @launch grid=(256,1,1) block=(256,1,1) lds=159744
.amdgcn_target "amdgcn-amd-amdhsa--gfx950"
.text
.globl standalone__detection_seg_fpn_lateral__vision_kernel
.p2align 12
.type standalone__detection_seg_fpn_lateral__vision_kernel,@function
standalone__detection_seg_fpn_lateral__vision_kernel:
    s_load_dwordx2 s[24:25], s[0:1], 16
    s_load_dwordx2 s[16:17], s[0:1], 0
    s_load_dwordx2 s[20:21], s[0:1], 8
    s_load_dwordx2 s[28:29], s[0:1], 24
    s_load_dwordx2 s[32:33], s[0:1], 32
    s_cmp_ge_u32 s2, 256
    s_cbranch_scc1 L_END
    v_lshrrev_b32 v185, 6, v0
    v_and_b32 v180, 63, v0
    v_readfirstlane_b32 s36, v185
    s_mov_b32 s18, 9633984
    s_mov_b32 s19, 0x20000
    s_mov_b32 s22, 2408640
    s_mov_b32 s23, 0x20000
    s_mov_b32 s26, 18432
    s_mov_b32 s27, 0x20000
    s_mov_b32 s30, 165888
    s_mov_b32 s31, 0x20000
    s_mov_b32 s34, 9633792
    s_mov_b32 s35, 0x20000
    v_lshrrev_b32 v182, 4, v180
    v_lshlrev_b32 v188, 4, v180
    v_mov_b32 v184, 0x40000000
    s_and_b32 s38, s36, 1
    s_lshr_b32 s37, s36, 1
    s_mul_i32 s47, s36, 3072
    s_lshr_b32 s42, s2, 3
    s_and_b32 s44, s2, 7
    s_lshl_b32 s44, s44, 1
    s_lshr_b32 s45, s2, 7
    s_add_u32 s44, s44, s45
    s_mul_i32 s40, s44, 14
    s_and_b32 s43, s42, 15
    s_mul_i32 s41, s43, 14
    v_add_u32 v185, 1, v182
    v_and_b32 v185, 4, v185
    v_lshlrev_b32 v185, 3, v185
    v_xor_b32 v250, v185, v188
    v_xor_b32 v251, 32, v188
    v_subrev_u32 v185, 1, v182
    v_and_b32 v185, 4, v185
    v_lshlrev_b32 v185, 3, v185
    v_xor_b32 v252, v185, v188
    s_cmp_eq_u32 s41, 0
    s_cselect_b32 s43, 12, 0
    s_cmp_eq_u32 s41, 210
    s_cselect_b32 s44, 52, 64
    s_cselect_b32 s45, 32, 44
    v_cmp_gt_u32 vcc, s43, v180
    v_and_b32 v185, 32, v180
    v_xor_b32 v254, v185, v188
    v_cndmask_b32 v253, v188, v184, vcc
    v_cmp_gt_u32 vcc, s44, v180
    s_mul_i32 s43, s38, 7
    s_add_u32 s43, s43, s37
    v_cndmask_b32 v255, v184, v251, vcc
    v_cmp_gt_u32 vcc, s45, v180
    s_mul_i32 s52, s43, 3072
    s_add_u32 s44, s43, s40
    v_cndmask_b32 v249, v184, v188, vcc
    s_sub_u32 s44, s44, 1
    s_mul_i32 s45, s41, 192
    s_mul_i32 s50, s44, 43008
    s_add_u32 s50, s50, s45
    s_ashr_i32 s49, s44, 1
    s_mul_i32 s51, s49, 21504
    s_lshr_b32 s45, s45, 1
    s_add_u32 s51, s51, s45
    s_add_u32 s53, s50, 86016
    s_add_u32 s54, s51, 21504
    s_add_u32 s55, s52, 6144
    s_add_u32 s56, s50, 172032
    s_add_u32 s57, s51, 43008
    s_add_u32 s58, s52, 12288
    s_cmp_lt_i32 s44, 0
    s_cselect_b32 s50, 0x40000000, s50
    s_cselect_b32 s51, 0x40000000, s51
    s_add_u32 s43, s36, 12
    s_cmp_eq_u32 s36, 0
    s_cselect_b32 s43, 6, s43
    s_mul_i32 s61, s43, 3072
    s_lshl_b32 s44, s42, 2
    s_add_u32 s44, s44, s36
    s_mul_i32 s5, s44, 1408
    v_lshlrev_b32 v185, 7, v180
    v_cmp_gt_u32 vcc, 11, v180
    s_nop 1
    v_cndmask_b32 v228, v184, v185, vcc
    s_mov_b32 s15, 0x20000
    s_cmp_lt_u32 s36, 2
    s_cselect_b32 s14, s26, s30
    s_cselect_b32 s7, 18432, 0
    s_add_u32 s7, s7, s47
    s_sub_u32 s7, s7, 6144
    s_waitcnt lgkmcnt(0)
    s_add_u32 m0, s47, 49152
    s_nop 0
    buffer_load_dwordx4 v250, s[24:27], s47 offen offset:0 lds
    buffer_load_dwordx4 v251, s[24:27], s47 offen offset:1024 lds
    buffer_load_dwordx4 v252, s[24:27], s47 offen offset:2048 lds
    s_cmp_lt_u32 s36, 2
    s_cselect_b32 s12, s24, s28
    s_cselect_b32 s13, s25, s29
    s_sub_u32 s16, s16, 192
    s_subb_u32 s17, s17, 0
    s_sub_u32 s20, s20, 192
    s_subb_u32 s21, s21, 0
    s_add_u32 m0, s47, 61440
    s_nop 0
    buffer_load_dwordx4 v250, s[12:15], s7 offen offset:0 lds
    buffer_load_dwordx4 v251, s[12:15], s7 offen offset:1024 lds
    buffer_load_dwordx4 v252, s[12:15], s7 offen offset:2048 lds
    s_mov_b32 m0, s52
    s_nop 0
    buffer_load_dwordx4 v253, s[16:19], s50 offen offset:0 lds
    buffer_load_dwordx4 v254, s[16:19], s50 offen offset:1024 lds
    buffer_load_dwordx4 v255, s[16:19], s50 offen offset:2048 lds
    s_mov_b32 m0, s58
    s_nop 0
    buffer_load_dwordx4 v253, s[20:23], s51 offen offset:0 lds
    buffer_load_dwordx4 v249, s[20:23], s51 offen offset:1024 lds
    buffer_load_dword v228, v228, s[28:31], s5 offen
    s_add_u32 s44, s43, s40
    s_sub_u32 s44, s44, 1
    s_mul_i32 s45, s41, 192
    s_mul_i32 s59, s44, 43008
    s_add_u32 s59, s59, s45
    s_lshr_b32 s49, s44, 1
    s_mul_i32 s60, s49, 21504
    s_lshr_b32 s45, s45, 1
    s_add_u32 s60, s60, s45
    s_cmp_lt_u32 s44, 224
    s_cselect_b32 s59, s59, 0x40000000
    s_cselect_b32 s60, s60, 0x40000000
    s_mul_i32 s39, s36, 5120
    s_add_u32 s39, s39, 122880
    s_add_u32 s6, s39, 3072
    s_mul_i32 s43, s37, 7
    s_add_u32 s43, s43, s40
    s_mul_i32 s48, s43, 43008
    v_and_b32 v181, 15, v180
    v_and_b32 v189, 1, v182
    v_lshrrev_b32 v185, 1, v182
    v_lshlrev_b32 v186, 5, v189
    v_lshl_add_u32 v190, v185, 4, v186
    v_add_u32 v185, s41, v181
    v_mul_u32_u24 v185, 192, v185
    s_mul_i32 s43, s38, 96
    v_add_u32 v185, s43, v185
    v_cmp_gt_u32 vcc, 14, v181
    v_add_u32 v186, v185, v190
    v_lshl_add_u32 v185, v182, 3, v185
    v_cndmask_b32 v245, v184, v186, vcc
    v_cndmask_b32 v246, v184, v185, vcc
    s_mul_i32 s43, s41, 192
    s_mul_i32 s44, s38, 1408
    s_add_u32 s43, s43, s44
    v_add_u32 v245, s43, v188
    s_lshl_b32 s44, s38, 3
    s_sub_u32 s44, 24, s44
    v_cmp_gt_u32 vcc, s44, v180
    v_add_u32 v185, 960, v245
    s_nop 0
    v_cndmask_b32 v246, v184, v185, vcc
    s_mul_i32 s43, s37, 21504
    v_lshlrev_b32 v185, 8, v182
    v_lshl_add_u32 v242, v181, 4, v185
    v_add_u32 v244, s43, v242
    v_lshrrev_b32 v185, 2, v181
    v_and_b32 v185, 2, v185
    v_xor_b32 v185, v185, v182
    v_mul_u32_u24 v186, 192, v181
    v_lshl_add_u32 v240, v185, 4, v186
    v_add_u32 v185, 1, v181
    v_lshrrev_b32 v185, 1, v185
    v_mul_u32_u24 v185, 192, v185
    v_lshl_add_u32 v241, v182, 3, v185
    v_bfe_u32 v183, v180, 2, 2
    v_and_b32 v184, 3, v180
    v_lshl_add_u32 v187, v182, 3, v183
    v_mul_u32_u24 v187, 192, v187
    v_add_u32 v187, 49152, v187
    v_lshl_add_u32 v187, v184, 3, v187
    v_lshl_add_u32 v192, v189, 5, v187
    v_xor_b32 v193, 32, v192
    v_lshl_add_u32 v187, v182, 2, v183
    v_mul_u32_u24 v187, 192, v187
    v_add_u32 v187, 49152, v187
    v_lshl_add_u32 v187, v184, 3, v187
    v_lshrrev_b32 v185, 1, v182
    v_xor_b32 v189, v189, v185
    s_mul_i32 s43, s38, 3
    v_xor_b32 v185, s43, v189
    v_lshl_add_u32 v247, v185, 5, v187
    s_add_u32 s43, s43, 1
    v_xor_b32 v185, s43, v189
    v_lshl_add_u32 v248, v185, 5, v187
    s_cmp_eq_u32 s36, 1
    s_cbranch_scc1 TSTUB1
TBACK1:
    s_cmp_eq_u32 s36, 2
    s_cbranch_scc1 TSTUB2
TBACK2:
    s_waitcnt vmcnt(6)
    s_barrier
    ds_read_b64_tr_b16 v[72:73], v192 offset:0
    ds_read_b64_tr_b16 v[74:75], v193 offset:768
    ds_read_b64_tr_b16 v[96:97], v192 offset:6144
    ds_read_b64_tr_b16 v[98:99], v193 offset:6912
    ds_read_b64_tr_b16 v[120:121], v192 offset:12288
    ds_read_b64_tr_b16 v[122:123], v193 offset:13056
    s_add_u32 m0, s47, 73728
    s_add_u32 s46, s47, 6144
    buffer_load_dwordx4 v250, s[28:31], s46 offen offset:0 lds
    buffer_load_dwordx4 v251, s[28:31], s46 offen offset:1024 lds
    buffer_load_dwordx4 v252, s[28:31], s46 offen offset:2048 lds
    ds_read_b64_tr_b16 v[76:77], v193 offset:0
    ds_read_b64_tr_b16 v[78:79], v192 offset:768
    ds_read_b64_tr_b16 v[100:101], v193 offset:6144
    ds_read_b64_tr_b16 v[102:103], v192 offset:6912
    ds_read_b64_tr_b16 v[124:125], v193 offset:12288
    ds_read_b64_tr_b16 v[126:127], v192 offset:13056
    ds_read_b64_tr_b16 v[80:81], v192 offset:64
    ds_read_b64_tr_b16 v[82:83], v193 offset:832
    ds_read_b64_tr_b16 v[104:105], v192 offset:6208
    ds_read_b64_tr_b16 v[106:107], v193 offset:6976
    ds_read_b64_tr_b16 v[128:129], v192 offset:12352
    ds_read_b64_tr_b16 v[130:131], v193 offset:13120
    s_add_u32 m0, s47, 86016
    s_add_u32 s46, s47, 18432
    buffer_load_dwordx4 v250, s[28:31], s46 offen offset:0 lds
    ds_read_b64_tr_b16 v[84:85], v193 offset:64
    ds_read_b64_tr_b16 v[86:87], v192 offset:832
    ds_read_b64_tr_b16 v[108:109], v193 offset:6208
    ds_read_b64_tr_b16 v[110:111], v192 offset:6976
    ds_read_b64_tr_b16 v[132:133], v193 offset:12352
    ds_read_b64_tr_b16 v[134:135], v192 offset:13120
    buffer_load_dwordx4 v251, s[28:31], s46 offen offset:1024 lds
    ds_read_b64_tr_b16 v[88:89], v192 offset:128
    ds_read_b64_tr_b16 v[90:91], v193 offset:896
    ds_read_b64_tr_b16 v[112:113], v192 offset:6272
    ds_read_b64_tr_b16 v[114:115], v193 offset:7040
    ds_read_b64_tr_b16 v[136:137], v192 offset:12416
    ds_read_b64_tr_b16 v[138:139], v193 offset:13184
    buffer_load_dwordx4 v252, s[28:31], s46 offen offset:2048 lds
    ds_read_b64_tr_b16 v[92:93], v193 offset:128
    ds_read_b64_tr_b16 v[94:95], v192 offset:896
    ds_read_b64_tr_b16 v[116:117], v193 offset:6272
    ds_read_b64_tr_b16 v[118:119], v192 offset:7040
    ds_read_b64_tr_b16 v[140:141], v193 offset:12416
    ds_read_b64_tr_b16 v[142:143], v192 offset:13184
    ds_read_b64_tr_b16 a[0:1], v247 offset:18432
    ds_read_b64_tr_b16 a[2:3], v247 offset:21504
    ds_read_b64_tr_b16 a[4:5], v248 offset:18432
    ds_read_b64_tr_b16 a[6:7], v248 offset:21504
    ds_read_b64_tr_b16 a[8:9], v247 offset:18496
    ds_read_b64_tr_b16 a[10:11], v247 offset:21568
    s_add_u32 m0, s47, 98304
    s_add_u32 s46, s47, 30720
    buffer_load_dwordx4 v250, s[28:31], s46 offen offset:0 lds
    buffer_load_dwordx4 v251, s[28:31], s46 offen offset:1024 lds
    buffer_load_dwordx4 v252, s[28:31], s46 offen offset:2048 lds
    s_mov_b32 m0, s55
    s_nop 0
    buffer_load_dwordx4 v253, s[16:19], s53 offen offset:0 lds
    v_add_u32 v243, s52, v240
    v_add_u32 v195, s58, v241
    s_waitcnt vmcnt(11)
    ds_read_b64 v[156:157], v195 offset:0
    ds_read_b128 v[168:171], v243 offset:0
    ds_read_b128 v[172:175], v243 offset:64
    ds_read_b128 v[176:179], v243 offset:128
    ds_read_b64 v[158:159], v195 offset:32
    ds_read_b64 v[160:161], v195 offset:64
    ds_read_b64 v[162:163], v195 offset:96
    ds_read_b64 v[164:165], v195 offset:128
    ds_read_b64 v[166:167], v195 offset:160
    s_waitcnt lgkmcnt(8)
    v_lshlrev_b32 v144, 16, v156
    v_and_b32 v145, 0xffff0000, v156
    v_lshlrev_b32 v146, 16, v157
    v_and_b32 v147, 0xffff0000, v157
    s_waitcnt lgkmcnt(7)
    s_nop 0
    v_mfma_f32_16x16x32_bf16 v[144:147], v[72:75], v[168:171], v[144:147]
    buffer_load_dwordx4 v254, s[16:19], s53 offen offset:1024 lds
    s_waitcnt lgkmcnt(4)
    v_lshlrev_b32 v148, 16, v158
    v_and_b32 v149, 0xffff0000, v158
    v_lshlrev_b32 v150, 16, v159
    v_and_b32 v151, 0xffff0000, v159
    v_mfma_f32_16x16x32_bf16 v[144:147], v[96:99], v[172:175], v[144:147]
    s_waitcnt lgkmcnt(3)
    v_lshlrev_b32 v152, 16, v160
    v_and_b32 v153, 0xffff0000, v160
    v_lshlrev_b32 v154, 16, v161
    v_mfma_f32_16x16x32_bf16 v[144:147], v[120:123], v[176:179], v[144:147]
    v_and_b32 v155, 0xffff0000, v161
    s_waitcnt lgkmcnt(2)
    v_lshlrev_b32 v156, 16, v162
    v_mfma_f32_16x16x32_bf16 v[148:151], v[76:79], v[168:171], v[148:151]
    buffer_load_dwordx4 v255, s[16:19], s53 offen offset:2048 lds
    v_and_b32 v157, 0xffff0000, v162
    v_mfma_f32_16x16x32_bf16 v[148:151], v[100:103], v[172:175], v[148:151]
    v_lshlrev_b32 v158, 16, v163
    v_and_b32 v159, 0xffff0000, v163
    s_waitcnt lgkmcnt(0)
    v_lshlrev_b32 v160, 16, v164
    v_mfma_f32_16x16x32_bf16 v[148:151], v[124:127], v[176:179], v[148:151]
    v_and_b32 v161, 0xffff0000, v164
    v_lshlrev_b32 v162, 16, v165
    v_and_b32 v163, 0xffff0000, v165
    v_mfma_f32_16x16x32_bf16 v[152:155], v[80:83], v[168:171], v[152:155]
    v_lshlrev_b32 v164, 16, v166
    v_and_b32 v165, 0xffff0000, v166
    v_lshlrev_b32 v166, 16, v167
    v_mfma_f32_16x16x32_bf16 v[152:155], v[104:107], v[172:175], v[152:155]
    s_mov_b32 m0, s61
    s_nop 0
    buffer_load_dwordx4 v253, s[20:23], s54 offen offset:0 lds
    v_mfma_f32_16x16x32_bf16 v[152:155], v[128:131], v[176:179], v[152:155]
    v_and_b32 v167, 0xffff0000, v167
    v_add_u32 v243, s52, v242
    v_cvt_pk_bf16_f32 v144, v144, v145
    v_mfma_f32_16x16x32_bf16 v[156:159], v[84:87], v[168:171], v[156:159]
    v_cvt_pk_bf16_f32 v145, v146, v147
    v_cvt_pk_bf16_f32 v146, v148, v149
    v_cvt_pk_bf16_f32 v147, v150, v151
    v_mfma_f32_16x16x32_bf16 v[156:159], v[108:111], v[172:175], v[156:159]
    ds_write_b128 v243, v[144:147] offset:0
    v_cvt_pk_bf16_f32 v148, v152, v153
    v_cvt_pk_bf16_f32 v149, v154, v155
    v_mfma_f32_16x16x32_bf16 v[156:159], v[132:135], v[176:179], v[156:159]
    buffer_load_dwordx4 v249, s[20:23], s54 offen offset:1024 lds
    v_mfma_f32_16x16x32_bf16 v[160:163], v[88:91], v[168:171], v[160:163]
    s_nop 2
    v_mfma_f32_16x16x32_bf16 v[160:163], v[112:115], v[172:175], v[160:163]
    s_nop 1
    v_cvt_pk_bf16_f32 v150, v156, v157
    v_cvt_pk_bf16_f32 v151, v158, v159
    v_mfma_f32_16x16x32_bf16 v[160:163], v[136:139], v[176:179], v[160:163]
    ds_write_b128 v243, v[148:151] offset:1024
    s_nop 0
    v_mfma_f32_16x16x32_bf16 v[164:167], v[92:95], v[168:171], v[164:167]
    s_nop 2
    v_mfma_f32_16x16x32_bf16 v[164:167], v[116:119], v[172:175], v[164:167]
    s_add_u32 m0, s47, 110592
    s_add_u32 s46, s47, 43008
    buffer_load_dwordx4 v250, s[28:31], s46 offen offset:0 lds
    v_mfma_f32_16x16x32_bf16 v[164:167], v[140:143], v[176:179], v[164:167]
    v_cvt_pk_bf16_f32 v152, v160, v161
    v_cvt_pk_bf16_f32 v153, v162, v163
    s_nop 5
    v_cvt_pk_bf16_f32 v154, v164, v165
    v_cvt_pk_bf16_f32 v155, v166, v167
    ds_write_b128 v243, v[152:155] offset:2048
    s_waitcnt lgkmcnt(0)
    s_waitcnt vmcnt(6)
    s_barrier
    ds_read_b128 v[228:231], v244 offset:0
    ds_read_b128 a[216:219], v244 offset:3072
    ds_read_b64_tr_b16 a[12:13], v247 offset:24576
    ds_read_b64_tr_b16 a[14:15], v247 offset:27648
    ds_read_b64_tr_b16 a[16:17], v248 offset:24576
    ds_read_b64_tr_b16 a[18:19], v248 offset:27648
    ds_read_b64_tr_b16 a[20:21], v247 offset:24640
    ds_read_b64_tr_b16 a[22:23], v247 offset:27712
    ds_read_b128 v[232:235], v244 offset:1024
    ds_read_b128 a[220:223], v244 offset:4096
    s_waitcnt lgkmcnt(9)
    v_mfma_f32_16x16x32_bf16 v[180:183], a[0:3], v[228:231], 0
    buffer_load_dwordx4 v251, s[28:31], s46 offen offset:1024 lds
    ds_read_b64_tr_b16 a[24:25], v247 offset:30720
    ds_read_b64_tr_b16 a[26:27], v247 offset:33792
    v_mfma_f32_16x16x32_bf16 v[184:187], a[4:7], v[228:231], 0
    ds_read_b64_tr_b16 a[28:29], v248 offset:30720
    ds_read_b64_tr_b16 a[30:31], v248 offset:33792
    ds_read_b64_tr_b16 a[32:33], v247 offset:30784
    v_mfma_f32_16x16x32_bf16 v[188:191], a[8:11], v[228:231], 0
    ds_read_b64_tr_b16 a[34:35], v247 offset:33856
    ds_read_b128 v[236:239], v244 offset:2048
    ds_read_b128 a[224:227], v244 offset:5120
    s_waitcnt lgkmcnt(12)
    v_mfma_f32_16x16x32_bf16 v[192:195], a[0:3], a[216:219], 0
    buffer_load_dwordx4 v252, s[28:31], s46 offen offset:2048 lds
    ds_read_b128 a[252:255], v244 offset:16
    ds_read_b64_tr_b16 a[36:37], v247 offset:36864
    v_mfma_f32_16x16x32_bf16 v[196:199], a[4:7], a[216:219], 0
    ds_read_b64_tr_b16 a[38:39], v247 offset:39936
    ds_read_b64_tr_b16 a[40:41], v248 offset:36864
    ds_read_b64_tr_b16 a[42:43], v248 offset:39936
    v_mfma_f32_16x16x32_bf16 v[200:203], a[8:11], a[216:219], 0
    ds_read_b64_tr_b16 a[44:45], v247 offset:36928
    ds_read_b64_tr_b16 a[46:47], v247 offset:40000
    ds_read_b64_tr_b16 a[48:49], v247 offset:43008
    s_waitcnt lgkmcnt(15)
    v_mfma_f32_16x16x32_bf16 v[180:183], a[12:15], v[232:235], v[180:183]
    s_add_u32 m0, s47, 122880
    s_add_u32 s46, s47, 55296
    buffer_load_dwordx4 v250, s[28:31], s46 offen offset:0 lds
    ds_read_b64_tr_b16 a[50:51], v247 offset:46080
    ds_read_b64_tr_b16 a[52:53], v248 offset:43008
    v_mfma_f32_16x16x32_bf16 v[184:187], a[16:19], v[232:235], v[184:187]
    ds_read_b64_tr_b16 a[54:55], v248 offset:46080
    ds_read_b64_tr_b16 a[56:57], v247 offset:43072
    ds_read_b64_tr_b16 a[58:59], v247 offset:46144
    v_mfma_f32_16x16x32_bf16 v[188:191], a[20:23], v[232:235], v[188:191]
    ds_read_b64_tr_b16 a[60:61], v247 offset:49152
    ds_read_b64_tr_b16 a[62:63], v247 offset:52224
    ds_read_b64_tr_b16 a[64:65], v248 offset:49152
    v_mfma_f32_16x16x32_bf16 v[192:195], a[12:15], a[220:223], v[192:195]
    buffer_load_dwordx4 v251, s[28:31], s46 offen offset:1024 lds
    ds_read_b64_tr_b16 a[66:67], v248 offset:52224
    ds_read_b64_tr_b16 a[68:69], v247 offset:49216
    v_mfma_f32_16x16x32_bf16 v[196:199], a[16:19], a[220:223], v[196:199]
    ds_read_b64_tr_b16 a[70:71], v247 offset:52288
    ds_read_b128 v[228:231], v244 offset:1040
    ds_read_b128 v[0:3], v244 offset:3088
    v_mfma_f32_16x16x32_bf16 v[200:203], a[20:23], a[220:223], v[200:203]
    ds_read_b128 v[4:7], v244 offset:4112
    s_waitcnt lgkmcnt(14)
    v_mfma_f32_16x16x32_bf16 v[180:183], a[24:27], v[236:239], v[180:183]
    buffer_load_dwordx4 v252, s[28:31], s46 offen offset:2048 lds
    ds_read_b128 v[8:11], v244 offset:5136
    v_mfma_f32_16x16x32_bf16 v[184:187], a[28:31], v[236:239], v[184:187]
    ds_read_b128 v[232:235], v244 offset:2064
    v_mfma_f32_16x16x32_bf16 v[188:191], a[32:35], v[236:239], v[188:191]
    v_mfma_f32_16x16x32_bf16 v[192:195], a[24:27], a[224:227], v[192:195]
    v_mfma_f32_16x16x32_bf16 v[196:199], a[28:31], a[224:227], v[196:199]
    v_mfma_f32_16x16x32_bf16 v[200:203], a[32:35], a[224:227], v[200:203]
    v_mfma_f32_16x16x32_bf16 v[180:183], a[36:39], a[252:255], v[180:183]
    v_mfma_f32_16x16x32_bf16 v[184:187], a[40:43], a[252:255], v[184:187]
    v_mfma_f32_16x16x32_bf16 v[188:191], a[44:47], a[252:255], v[188:191]
    s_waitcnt lgkmcnt(4)
    v_mfma_f32_16x16x32_bf16 v[180:183], a[48:51], v[228:231], v[180:183]
    v_mfma_f32_16x16x32_bf16 v[184:187], a[52:55], v[228:231], v[184:187]
    v_mfma_f32_16x16x32_bf16 v[188:191], a[56:59], v[228:231], v[188:191]
    s_waitcnt lgkmcnt(0)
    v_mfma_f32_16x16x32_bf16 v[180:183], a[60:63], v[232:235], v[180:183]
    v_add_u32 v243, s55, v240
    v_add_u32 v204, s61, v241
    s_waitcnt vmcnt(6)
    ds_read_b64 v[156:157], v204 offset:0
    ds_read_b128 v[168:171], v243 offset:0
    v_mfma_f32_16x16x32_bf16 v[184:187], a[64:67], v[232:235], v[184:187]
    s_add_u32 m0, s47, 135168
    s_add_u32 s46, s47, 67584
    buffer_load_dwordx4 v250, s[28:31], s46 offen offset:0 lds
    v_mfma_f32_16x16x32_bf16 v[188:191], a[68:71], v[232:235], v[188:191]
    ds_read_b128 v[172:175], v243 offset:64
    v_mfma_f32_16x16x32_bf16 v[192:195], a[36:39], v[0:3], v[192:195]
    ds_read_b128 v[176:179], v243 offset:128
    v_mfma_f32_16x16x32_bf16 v[196:199], a[40:43], v[0:3], v[196:199]
    ds_read_b64 v[158:159], v204 offset:32
    v_mfma_f32_16x16x32_bf16 v[200:203], a[44:47], v[0:3], v[200:203]
    buffer_load_dwordx4 v251, s[28:31], s46 offen offset:1024 lds
    ds_read_b64 v[160:161], v204 offset:64
    v_mfma_f32_16x16x32_bf16 v[192:195], a[48:51], v[4:7], v[192:195]
    ds_read_b64 v[162:163], v204 offset:96
    v_mfma_f32_16x16x32_bf16 v[196:199], a[52:55], v[4:7], v[196:199]
    ds_read_b64 v[164:165], v204 offset:128
    s_waitcnt lgkmcnt(7)
    v_lshlrev_b32 v144, 16, v156
    v_mfma_f32_16x16x32_bf16 v[200:203], a[56:59], v[4:7], v[200:203]
    ds_read_b64 v[166:167], v204 offset:160
    v_and_b32 v145, 0xffff0000, v156
    v_mfma_f32_16x16x32_bf16 v[192:195], a[60:63], v[8:11], v[192:195]
    buffer_load_dwordx4 v252, s[28:31], s46 offen offset:2048 lds
    v_lshlrev_b32 v146, 16, v157
    v_and_b32 v147, 0xffff0000, v157
    s_waitcnt vmcnt(6)
    s_barrier
    v_mfma_f32_16x16x32_bf16 v[196:199], a[64:67], v[8:11], v[196:199]
    v_add_u32 v247, 55296, v247
    v_add_u32 v248, 55296, v248
    ds_read_b64_tr_b16 a[72:73], v247 offset:0
    ds_read_b64_tr_b16 a[74:75], v247 offset:3072
    ds_read_b64_tr_b16 a[76:77], v248 offset:0
    v_mfma_f32_16x16x32_bf16 v[200:203], a[68:71], v[8:11], v[200:203]
    s_add_u32 m0, s47, 147456
    s_add_u32 s46, s47, 79872
    buffer_load_dwordx4 v250, s[28:31], s46 offen offset:0 lds
    ds_read_b64_tr_b16 a[78:79], v248 offset:3072
    ds_read_b64_tr_b16 a[80:81], v247 offset:64
    s_waitcnt lgkmcnt(8)
    v_lshlrev_b32 v148, 16, v158
    v_and_b32 v149, 0xffff0000, v158
    v_mfma_f32_16x16x32_bf16 v[144:147], v[72:75], v[168:171], v[144:147]
    ds_read_b64_tr_b16 a[82:83], v247 offset:3136
    ds_read_b64_tr_b16 a[84:85], v247 offset:6144
    ds_read_b64_tr_b16 a[86:87], v247 offset:9216
    v_lshlrev_b32 v150, 16, v159
    v_and_b32 v151, 0xffff0000, v159
    v_mfma_f32_16x16x32_bf16 v[144:147], v[96:99], v[172:175], v[144:147]
    buffer_load_dwordx4 v251, s[28:31], s46 offen offset:1024 lds
    ds_read_b64_tr_b16 a[88:89], v248 offset:6144
    ds_read_b64_tr_b16 a[90:91], v248 offset:9216
    v_mfma_f32_16x16x32_bf16 v[144:147], v[120:123], v[176:179], v[144:147]
    ds_read_b64_tr_b16 a[92:93], v247 offset:6208
    ds_read_b64_tr_b16 a[94:95], v247 offset:9280
    ds_read_b64_tr_b16 a[96:97], v247 offset:12288
    v_lshlrev_b32 v152, 16, v160
    v_and_b32 v153, 0xffff0000, v160
    v_mfma_f32_16x16x32_bf16 v[148:151], v[76:79], v[168:171], v[148:151]
    ds_read_b64_tr_b16 a[98:99], v247 offset:15360
    ds_read_b64_tr_b16 a[100:101], v248 offset:12288
    v_lshlrev_b32 v154, 16, v161
    v_and_b32 v155, 0xffff0000, v161
    v_mfma_f32_16x16x32_bf16 v[148:151], v[100:103], v[172:175], v[148:151]
    buffer_load_dwordx4 v252, s[28:31], s46 offen offset:2048 lds
    ds_read_b64_tr_b16 a[102:103], v248 offset:15360
    v_mfma_f32_16x16x32_bf16 v[148:151], v[124:127], v[176:179], v[148:151]
    ds_read_b64_tr_b16 a[104:105], v247 offset:12352
    s_waitcnt lgkmcnt(12)
    v_lshlrev_b32 v156, 16, v162
    v_and_b32 v157, 0xffff0000, v162
    v_mfma_f32_16x16x32_bf16 v[152:155], v[80:83], v[168:171], v[152:155]
    ds_read_b64_tr_b16 a[106:107], v247 offset:15424
    v_lshlrev_b32 v158, 16, v163
    v_and_b32 v159, 0xffff0000, v163
    v_mfma_f32_16x16x32_bf16 v[152:155], v[104:107], v[172:175], v[152:155]
    ds_read_b128 v[236:239], v244 offset:32
    v_lshlrev_b32 v160, 16, v164
    v_mfma_f32_16x16x32_bf16 v[152:155], v[128:131], v[176:179], v[152:155]
    s_add_u32 m0, s47, 49152
    s_add_u32 s46, s47, 92160
    buffer_load_dwordx4 v250, s[28:31], s46 offen offset:0 lds
    v_and_b32 v161, 0xffff0000, v164
    v_mfma_f32_16x16x32_bf16 v[156:159], v[84:87], v[168:171], v[156:159]
    ds_read_b128 a[252:255], v244 offset:1056
    v_lshlrev_b32 v162, 16, v165
    v_and_b32 v163, 0xffff0000, v165
    v_mfma_f32_16x16x32_bf16 v[156:159], v[108:111], v[172:175], v[156:159]
    ds_read_b128 v[228:231], v244 offset:2080
    v_lshlrev_b32 v164, 16, v166
    v_mfma_f32_16x16x32_bf16 v[156:159], v[132:135], v[176:179], v[156:159]
    ds_read_b128 v[36:39], v244 offset:3104
    v_and_b32 v165, 0xffff0000, v166
    v_mfma_f32_16x16x32_bf16 v[160:163], v[88:91], v[168:171], v[160:163]
    buffer_load_dwordx4 v251, s[28:31], s46 offen offset:1024 lds
    v_lshlrev_b32 v166, 16, v167
    v_and_b32 v167, 0xffff0000, v167
    v_mfma_f32_16x16x32_bf16 v[160:163], v[112:115], v[172:175], v[160:163]
    ds_read_b128 v[40:43], v244 offset:4128
    v_add_u32 v243, s55, v242
    v_mfma_f32_16x16x32_bf16 v[160:163], v[136:139], v[176:179], v[160:163]
    ds_read_b128 v[44:47], v244 offset:5152
    v_cvt_pk_bf16_f32 v144, v144, v145
    v_mfma_f32_16x16x32_bf16 v[164:167], v[92:95], v[168:171], v[164:167]
    v_cvt_pk_bf16_f32 v145, v146, v147
    v_cvt_pk_bf16_f32 v146, v148, v149
    v_mfma_f32_16x16x32_bf16 v[164:167], v[116:119], v[172:175], v[164:167]
    buffer_load_dwordx4 v252, s[28:31], s46 offen offset:2048 lds
    v_mfma_f32_16x16x32_bf16 v[164:167], v[140:143], v[176:179], v[164:167]
    v_cvt_pk_bf16_f32 v147, v150, v151
    ds_write_b128 v243, v[144:147] offset:0
    s_waitcnt lgkmcnt(6)
    v_mfma_f32_16x16x32_bf16 v[180:183], a[72:75], v[236:239], v[180:183]
    v_cvt_pk_bf16_f32 v148, v152, v153
    v_cvt_pk_bf16_f32 v149, v154, v155
    v_mfma_f32_16x16x32_bf16 v[184:187], a[76:79], v[236:239], v[184:187]
    v_cvt_pk_bf16_f32 v150, v156, v157
    v_cvt_pk_bf16_f32 v151, v158, v159
    v_mfma_f32_16x16x32_bf16 v[188:191], a[80:83], v[236:239], v[188:191]
    s_add_u32 m0, s47, 61440
    s_add_u32 s46, s47, 104448
    buffer_load_dwordx4 v250, s[28:31], s46 offen offset:0 lds
    s_waitcnt lgkmcnt(3)
    v_mfma_f32_16x16x32_bf16 v[180:183], a[84:87], a[252:255], v[180:183]
    ds_write_b128 v243, v[148:151] offset:1024
    v_cvt_pk_bf16_f32 v152, v160, v161
    v_mfma_f32_16x16x32_bf16 v[184:187], a[88:91], a[252:255], v[184:187]
    v_cvt_pk_bf16_f32 v153, v162, v163
    v_cvt_pk_bf16_f32 v154, v164, v165
    v_mfma_f32_16x16x32_bf16 v[188:191], a[92:95], a[252:255], v[188:191]
    v_cvt_pk_bf16_f32 v155, v166, v167
    ds_write_b128 v243, v[152:155] offset:2048
    v_mfma_f32_16x16x32_bf16 v[180:183], a[96:99], v[228:231], v[180:183]
    buffer_load_dwordx4 v251, s[28:31], s46 offen offset:1024 lds
    v_mfma_f32_16x16x32_bf16 v[184:187], a[100:103], v[228:231], v[184:187]
    v_mfma_f32_16x16x32_bf16 v[188:191], a[104:107], v[228:231], v[188:191]
    s_waitcnt lgkmcnt(0)
    s_waitcnt vmcnt(8)
    s_barrier
    v_mfma_f32_16x16x32_bf16 v[192:195], a[72:75], v[36:39], v[192:195]
    buffer_load_dwordx4 v252, s[28:31], s46 offen offset:2048 lds
    ds_read_b128 a[228:231], v244 offset:6144
    v_mfma_f32_16x16x32_bf16 v[196:199], a[76:79], v[36:39], v[196:199]
    ds_read_b128 a[232:235], v244 offset:7168
    v_mfma_f32_16x16x32_bf16 v[200:203], a[80:83], v[36:39], v[200:203]
    ds_read_b128 a[236:239], v244 offset:8192
    v_mfma_f32_16x16x32_bf16 v[192:195], a[84:87], v[40:43], v[192:195]
    ds_read_b128 a[240:243], v244 offset:9216
    v_mfma_f32_16x16x32_bf16 v[196:199], a[88:91], v[40:43], v[196:199]
    s_add_u32 m0, s47, 73728
    s_add_u32 s46, s47, 116736
    buffer_load_dwordx4 v250, s[28:31], s46 offen offset:0 lds
    v_mfma_f32_16x16x32_bf16 v[200:203], a[92:95], v[40:43], v[200:203]
    ds_read_b128 a[244:247], v244 offset:10240
    v_mfma_f32_16x16x32_bf16 v[192:195], a[96:99], v[44:47], v[192:195]
    ds_read_b128 a[248:251], v244 offset:11264
    v_mfma_f32_16x16x32_bf16 v[196:199], a[100:103], v[44:47], v[196:199]
    ds_read_b128 v[12:15], v244 offset:6160
    v_mfma_f32_16x16x32_bf16 v[200:203], a[104:107], v[44:47], v[200:203]
    buffer_load_dwordx4 v251, s[28:31], s46 offen offset:1024 lds
    s_waitcnt vmcnt(8)
    s_barrier
    s_waitcnt lgkmcnt(6)
    v_mfma_f32_16x16x32_bf16 v[204:207], a[0:3], a[228:231], 0
    s_branch TOVER1
TSTUB1:
    s_branch TBACK1
TOVER1:
    ds_read_b128 v[16:19], v244 offset:7184
    v_mfma_f32_16x16x32_bf16 v[208:211], a[4:7], a[228:231], 0
    ds_read_b128 v[20:23], v244 offset:8208
    v_mfma_f32_16x16x32_bf16 v[212:215], a[8:11], a[228:231], 0
    ds_read_b128 v[24:27], v244 offset:9232
    s_waitcnt lgkmcnt(7)
    v_mfma_f32_16x16x32_bf16 v[204:207], a[12:15], a[232:235], v[204:207]
    buffer_load_dwordx4 v252, s[28:31], s46 offen offset:2048 lds
    v_mfma_f32_16x16x32_bf16 v[208:211], a[16:19], a[232:235], v[208:211]
    ds_read_b128 v[28:31], v244 offset:10256
    v_mfma_f32_16x16x32_bf16 v[212:215], a[20:23], a[232:235], v[212:215]
    ds_read_b128 v[32:35], v244 offset:11280
    v_mfma_f32_16x16x32_bf16 v[204:207], a[24:27], a[236:239], v[204:207]
    ds_read_b128 v[48:51], v244 offset:6176
    v_mfma_f32_16x16x32_bf16 v[208:211], a[28:31], a[236:239], v[208:211]
    ds_read_b128 v[52:55], v244 offset:7200
    v_mfma_f32_16x16x32_bf16 v[212:215], a[32:35], a[236:239], v[212:215]
    s_add_u32 m0, s47, 86016
    s_add_u32 s46, s47, 129024
    buffer_load_dwordx4 v250, s[28:31], s46 offen offset:0 lds
    s_waitcnt lgkmcnt(7)
    v_mfma_f32_16x16x32_bf16 v[216:219], a[0:3], a[240:243], 0
    ds_read_b128 v[56:59], v244 offset:8224
    v_mfma_f32_16x16x32_bf16 v[220:223], a[4:7], a[240:243], 0
    ds_read_b128 v[60:63], v244 offset:9248
    v_mfma_f32_16x16x32_bf16 v[224:227], a[8:11], a[240:243], 0
    ds_read_b128 v[64:67], v244 offset:10272
    v_mfma_f32_16x16x32_bf16 v[216:219], a[12:15], a[244:247], v[216:219]
    buffer_load_dwordx4 v251, s[28:31], s46 offen offset:1024 lds
    v_mfma_f32_16x16x32_bf16 v[220:223], a[16:19], a[244:247], v[220:223]
    ds_read_b128 v[68:71], v244 offset:11296
    v_mfma_f32_16x16x32_bf16 v[224:227], a[20:23], a[244:247], v[224:227]
    ds_read_b64_tr_b16 a[108:109], v247 offset:18432
    v_mfma_f32_16x16x32_bf16 v[216:219], a[24:27], a[248:251], v[216:219]
    ds_read_b64_tr_b16 a[110:111], v247 offset:21504
    v_mfma_f32_16x16x32_bf16 v[220:223], a[28:31], a[248:251], v[220:223]
    ds_read_b64_tr_b16 a[112:113], v248 offset:18432
    v_mfma_f32_16x16x32_bf16 v[224:227], a[32:35], a[248:251], v[224:227]
    buffer_load_dwordx4 v252, s[28:31], s46 offen offset:2048 lds
    v_mfma_f32_16x16x32_bf16 v[204:207], a[36:39], v[12:15], v[204:207]
    ds_read_b64_tr_b16 a[114:115], v248 offset:21504
    v_mfma_f32_16x16x32_bf16 v[208:211], a[40:43], v[12:15], v[208:211]
    ds_read_b64_tr_b16 a[116:117], v247 offset:18496
    v_mfma_f32_16x16x32_bf16 v[212:215], a[44:47], v[12:15], v[212:215]
    ds_read_b64_tr_b16 a[118:119], v247 offset:21568
    s_waitcnt lgkmcnt(8)
    v_mfma_f32_16x16x32_bf16 v[204:207], a[48:51], v[16:19], v[204:207]
    ds_read_b64_tr_b16 a[120:121], v247 offset:24576
    v_mfma_f32_16x16x32_bf16 v[208:211], a[52:55], v[16:19], v[208:211]
    s_add_u32 m0, s47, 98304
    s_add_u32 s46, s47, 141312
    buffer_load_dwordx4 v250, s[28:31], s46 offen offset:0 lds
    v_mfma_f32_16x16x32_bf16 v[212:215], a[56:59], v[16:19], v[212:215]
    ds_read_b64_tr_b16 a[122:123], v247 offset:27648
    v_mfma_f32_16x16x32_bf16 v[204:207], a[60:63], v[20:23], v[204:207]
    ds_read_b64_tr_b16 a[124:125], v248 offset:24576
    v_mfma_f32_16x16x32_bf16 v[208:211], a[64:67], v[20:23], v[208:211]
    ds_read_b64_tr_b16 a[126:127], v248 offset:27648
    v_mfma_f32_16x16x32_bf16 v[212:215], a[68:71], v[20:23], v[212:215]
    buffer_load_dwordx4 v251, s[28:31], s46 offen offset:1024 lds
    v_mfma_f32_16x16x32_bf16 v[216:219], a[36:39], v[24:27], v[216:219]
    ds_read_b64_tr_b16 a[128:129], v247 offset:24640
    v_mfma_f32_16x16x32_bf16 v[220:223], a[40:43], v[24:27], v[220:223]
    ds_read_b64_tr_b16 a[130:131], v247 offset:27712
    v_mfma_f32_16x16x32_bf16 v[224:227], a[44:47], v[24:27], v[224:227]
    ds_read_b64_tr_b16 a[132:133], v247 offset:30720
    v_mfma_f32_16x16x32_bf16 v[216:219], a[48:51], v[28:31], v[216:219]
    ds_read_b64_tr_b16 a[134:135], v247 offset:33792
    v_mfma_f32_16x16x32_bf16 v[220:223], a[52:55], v[28:31], v[220:223]
    buffer_load_dwordx4 v252, s[28:31], s46 offen offset:2048 lds
    v_mfma_f32_16x16x32_bf16 v[224:227], a[56:59], v[28:31], v[224:227]
    ds_read_b64_tr_b16 a[136:137], v248 offset:30720
    v_mfma_f32_16x16x32_bf16 v[216:219], a[60:63], v[32:35], v[216:219]
    ds_read_b64_tr_b16 a[138:139], v248 offset:33792
    v_mfma_f32_16x16x32_bf16 v[220:223], a[64:67], v[32:35], v[220:223]
    ds_read_b64_tr_b16 a[140:141], v247 offset:30784
    v_mfma_f32_16x16x32_bf16 v[224:227], a[68:71], v[32:35], v[224:227]
    ds_read_b64_tr_b16 a[142:143], v247 offset:33856
    v_mfma_f32_16x16x32_bf16 v[204:207], a[72:75], v[48:51], v[204:207]
    s_add_u32 m0, s47, 110592
    s_add_u32 s46, s47, 153600
    buffer_load_dwordx4 v250, s[28:31], s46 offen offset:0 lds
    v_mfma_f32_16x16x32_bf16 v[208:211], a[76:79], v[48:51], v[208:211]
    ds_read_b64_tr_b16 a[144:145], v247 offset:36864
    v_mfma_f32_16x16x32_bf16 v[212:215], a[80:83], v[48:51], v[212:215]
    ds_read_b64_tr_b16 a[146:147], v247 offset:39936
    v_mfma_f32_16x16x32_bf16 v[204:207], a[84:87], v[52:55], v[204:207]
    ds_read_b64_tr_b16 a[148:149], v248 offset:36864
    v_mfma_f32_16x16x32_bf16 v[208:211], a[88:91], v[52:55], v[208:211]
    buffer_load_dwordx4 v251, s[28:31], s46 offen offset:1024 lds
    v_mfma_f32_16x16x32_bf16 v[212:215], a[92:95], v[52:55], v[212:215]
    ds_read_b64_tr_b16 a[150:151], v248 offset:39936
    v_mfma_f32_16x16x32_bf16 v[204:207], a[96:99], v[56:59], v[204:207]
    ds_read_b64_tr_b16 a[152:153], v247 offset:36928
    v_mfma_f32_16x16x32_bf16 v[208:211], a[100:103], v[56:59], v[208:211]
    ds_read_b64_tr_b16 a[154:155], v247 offset:40000
    v_mfma_f32_16x16x32_bf16 v[212:215], a[104:107], v[56:59], v[212:215]
    ds_read_b64_tr_b16 a[156:157], v247 offset:43008
    v_mfma_f32_16x16x32_bf16 v[216:219], a[72:75], v[60:63], v[216:219]
    buffer_load_dwordx4 v252, s[28:31], s46 offen offset:2048 lds
    v_mfma_f32_16x16x32_bf16 v[220:223], a[76:79], v[60:63], v[220:223]
    ds_read_b64_tr_b16 a[158:159], v247 offset:46080
    v_mfma_f32_16x16x32_bf16 v[224:227], a[80:83], v[60:63], v[224:227]
    ds_read_b64_tr_b16 a[160:161], v248 offset:43008
    s_waitcnt lgkmcnt(8)
    v_mfma_f32_16x16x32_bf16 v[216:219], a[84:87], v[64:67], v[216:219]
    ds_read_b64_tr_b16 a[162:163], v248 offset:46080
    v_mfma_f32_16x16x32_bf16 v[220:223], a[88:91], v[64:67], v[220:223]
    ds_read_b64_tr_b16 a[164:165], v247 offset:43072
    v_mfma_f32_16x16x32_bf16 v[224:227], a[92:95], v[64:67], v[224:227]
    s_mov_b32 m0, s58
    s_nop 0
    buffer_load_dwordx4 v253, s[16:19], s56 offen offset:0 lds
    v_mfma_f32_16x16x32_bf16 v[216:219], a[96:99], v[68:71], v[216:219]
    ds_read_b64_tr_b16 a[166:167], v247 offset:46144
    v_mfma_f32_16x16x32_bf16 v[220:223], a[100:103], v[68:71], v[220:223]
    ds_read_b64_tr_b16 a[168:169], v247 offset:49152
    v_mfma_f32_16x16x32_bf16 v[224:227], a[104:107], v[68:71], v[224:227]
    ds_read_b64_tr_b16 a[170:171], v247 offset:52224
    s_waitcnt vmcnt(13)
    s_barrier
    v_mfma_f32_16x16x32_bf16 v[180:183], a[108:111], a[216:219], v[180:183]
    buffer_load_dwordx4 v254, s[16:19], s56 offen offset:1024 lds
    v_mfma_f32_16x16x32_bf16 v[184:187], a[112:115], a[216:219], v[184:187]
    ds_read_b64_tr_b16 a[172:173], v248 offset:49152
    v_mfma_f32_16x16x32_bf16 v[188:191], a[116:119], a[216:219], v[188:191]
    ds_read_b64_tr_b16 a[174:175], v248 offset:52224
    v_mfma_f32_16x16x32_bf16 v[180:183], a[120:123], a[220:223], v[180:183]
    ds_read_b64_tr_b16 a[176:177], v247 offset:49216
    v_mfma_f32_16x16x32_bf16 v[184:187], a[124:127], a[220:223], v[184:187]
    ds_read_b64_tr_b16 a[178:179], v247 offset:52288
    v_mfma_f32_16x16x32_bf16 v[188:191], a[128:131], a[220:223], v[188:191]
    buffer_load_dwordx4 v255, s[16:19], s56 offen offset:2048 lds
    v_mfma_f32_16x16x32_bf16 v[180:183], a[132:135], a[224:227], v[180:183]
    v_subrev_u32 v247, 55296, v247
    v_subrev_u32 v248, 55296, v248
    ds_read_b64_tr_b16 a[180:181], v247 offset:0
    v_mfma_f32_16x16x32_bf16 v[184:187], a[136:139], a[224:227], v[184:187]
    ds_read_b64_tr_b16 a[182:183], v247 offset:3072
    v_mfma_f32_16x16x32_bf16 v[188:191], a[140:143], a[224:227], v[188:191]
    ds_read_b64_tr_b16 a[184:185], v248 offset:0
    v_mfma_f32_16x16x32_bf16 v[192:195], a[108:111], a[228:231], v[192:195]
    s_mov_b32 m0, s61
    s_nop 0
    buffer_load_dwordx4 v253, s[20:23], s57 offen offset:0 lds
    v_mfma_f32_16x16x32_bf16 v[196:199], a[112:115], a[228:231], v[196:199]
    ds_read_b64_tr_b16 a[186:187], v248 offset:3072
    v_mfma_f32_16x16x32_bf16 v[200:203], a[116:119], a[228:231], v[200:203]
    ds_read_b64_tr_b16 a[188:189], v247 offset:64
    v_mfma_f32_16x16x32_bf16 v[192:195], a[120:123], a[232:235], v[192:195]
    ds_read_b64_tr_b16 a[190:191], v247 offset:3136
    v_mfma_f32_16x16x32_bf16 v[196:199], a[124:127], a[232:235], v[196:199]
    buffer_load_dwordx4 v249, s[20:23], s57 offen offset:1024 lds
    v_mfma_f32_16x16x32_bf16 v[200:203], a[128:131], a[232:235], v[200:203]
    ds_read_b64_tr_b16 a[192:193], v247 offset:6144
    v_mfma_f32_16x16x32_bf16 v[192:195], a[132:135], a[236:239], v[192:195]
    ds_read_b64_tr_b16 a[194:195], v247 offset:9216
    v_mfma_f32_16x16x32_bf16 v[196:199], a[136:139], a[236:239], v[196:199]
    ds_read_b64_tr_b16 a[196:197], v248 offset:6144
    v_mfma_f32_16x16x32_bf16 v[200:203], a[140:143], a[236:239], v[200:203]
    ds_read_b64_tr_b16 a[198:199], v248 offset:9216
    v_mfma_f32_16x16x32_bf16 v[204:207], a[108:111], a[240:243], v[204:207]
    ds_read_b64_tr_b16 a[200:201], v247 offset:6208
    v_mfma_f32_16x16x32_bf16 v[208:211], a[112:115], a[240:243], v[208:211]
    ds_read_b64_tr_b16 a[202:203], v247 offset:9280
    v_mfma_f32_16x16x32_bf16 v[212:215], a[116:119], a[240:243], v[212:215]
    ds_read_b64_tr_b16 a[204:205], v247 offset:12288
    v_mfma_f32_16x16x32_bf16 v[204:207], a[120:123], a[244:247], v[204:207]
    ds_read_b64_tr_b16 a[206:207], v247 offset:15360
    v_mfma_f32_16x16x32_bf16 v[208:211], a[124:127], a[244:247], v[208:211]
    ds_read_b64_tr_b16 a[208:209], v248 offset:12288
    v_mfma_f32_16x16x32_bf16 v[212:215], a[128:131], a[244:247], v[212:215]
    ds_read_b64_tr_b16 a[210:211], v248 offset:15360
    v_mfma_f32_16x16x32_bf16 v[204:207], a[132:135], a[248:251], v[204:207]
    ds_read_b64_tr_b16 a[212:213], v247 offset:12352
    v_mfma_f32_16x16x32_bf16 v[208:211], a[136:139], a[248:251], v[208:211]
    ds_read_b64_tr_b16 a[214:215], v247 offset:15424
    v_mfma_f32_16x16x32_bf16 v[212:215], a[140:143], a[248:251], v[212:215]
    s_waitcnt lgkmcnt(10)
    s_waitcnt vmcnt(14)
    s_barrier
    v_mfma_f32_16x16x32_bf16 v[180:183], a[144:147], v[0:3], v[180:183]
    s_mov_b32 m0, s39
    s_nop 0
    buffer_load_dwordx4 v253, s[16:19], s59 offen offset:0 lds
    v_mfma_f32_16x16x32_bf16 v[184:187], a[148:151], v[0:3], v[184:187]
    ds_read_b64_tr_b16 a[216:217], v247 offset:18432
    v_mfma_f32_16x16x32_bf16 v[188:191], a[152:155], v[0:3], v[188:191]
    ds_read_b64_tr_b16 a[218:219], v247 offset:21504
    v_mfma_f32_16x16x32_bf16 v[180:183], a[156:159], v[4:7], v[180:183]
    ds_read_b64_tr_b16 a[220:221], v248 offset:18432
    v_mfma_f32_16x16x32_bf16 v[184:187], a[160:163], v[4:7], v[184:187]
    buffer_load_dwordx4 v254, s[16:19], s59 offen offset:1024 lds
    v_mfma_f32_16x16x32_bf16 v[188:191], a[164:167], v[4:7], v[188:191]
    ds_read_b64_tr_b16 a[222:223], v248 offset:21504
    v_mfma_f32_16x16x32_bf16 v[180:183], a[168:171], v[8:11], v[180:183]
    ds_read_b64_tr_b16 a[224:225], v247 offset:18496
    v_mfma_f32_16x16x32_bf16 v[184:187], a[172:175], v[8:11], v[184:187]
    ds_read_b64_tr_b16 a[226:227], v247 offset:21568
    v_mfma_f32_16x16x32_bf16 v[188:191], a[176:179], v[8:11], v[188:191]
    ds_read_b64_tr_b16 a[228:229], v247 offset:24576
    v_mfma_f32_16x16x32_bf16 v[192:195], a[144:147], v[12:15], v[192:195]
    buffer_load_dwordx4 v255, s[16:19], s59 offen offset:2048 lds
    v_mfma_f32_16x16x32_bf16 v[196:199], a[148:151], v[12:15], v[196:199]
    ds_read_b64_tr_b16 a[230:231], v247 offset:27648
    v_mfma_f32_16x16x32_bf16 v[200:203], a[152:155], v[12:15], v[200:203]
    ds_read_b64_tr_b16 a[232:233], v248 offset:24576
    v_mfma_f32_16x16x32_bf16 v[192:195], a[156:159], v[16:19], v[192:195]
    ds_read_b64_tr_b16 a[234:235], v248 offset:27648
    v_mfma_f32_16x16x32_bf16 v[196:199], a[160:163], v[16:19], v[196:199]
    ds_read_b64_tr_b16 a[236:237], v247 offset:24640
    v_mfma_f32_16x16x32_bf16 v[200:203], a[164:167], v[16:19], v[200:203]
    s_mov_b32 m0, s6
    s_nop 0
    buffer_load_dwordx4 v253, s[20:23], s60 offen offset:0 lds
    v_mfma_f32_16x16x32_bf16 v[192:195], a[168:171], v[20:23], v[192:195]
    ds_read_b64_tr_b16 a[238:239], v247 offset:27712
    v_mfma_f32_16x16x32_bf16 v[196:199], a[172:175], v[20:23], v[196:199]
    ds_read_b64_tr_b16 a[240:241], v247 offset:30720
    v_mfma_f32_16x16x32_bf16 v[200:203], a[176:179], v[20:23], v[200:203]
    ds_read_b64_tr_b16 a[242:243], v247 offset:33792
    v_mfma_f32_16x16x32_bf16 v[204:207], a[144:147], v[24:27], v[204:207]
    buffer_load_dwordx4 v249, s[20:23], s60 offen offset:1024 lds
    v_mfma_f32_16x16x32_bf16 v[208:211], a[148:151], v[24:27], v[208:211]
    ds_read_b64_tr_b16 a[244:245], v248 offset:30720
    v_mfma_f32_16x16x32_bf16 v[212:215], a[152:155], v[24:27], v[212:215]
    ds_read_b64_tr_b16 a[246:247], v248 offset:33792
    v_mfma_f32_16x16x32_bf16 v[204:207], a[156:159], v[28:31], v[204:207]
    ds_read_b64_tr_b16 a[248:249], v247 offset:30784
    v_mfma_f32_16x16x32_bf16 v[208:211], a[160:163], v[28:31], v[208:211]
    ds_read_b64_tr_b16 a[250:251], v247 offset:33856
    v_mfma_f32_16x16x32_bf16 v[212:215], a[164:167], v[28:31], v[212:215]
    v_mfma_f32_16x16x32_bf16 v[204:207], a[168:171], v[32:35], v[204:207]
    v_mfma_f32_16x16x32_bf16 v[208:211], a[172:175], v[32:35], v[208:211]
    v_mfma_f32_16x16x32_bf16 v[212:215], a[176:179], v[32:35], v[212:215]
    s_waitcnt vmcnt(13)
    s_barrier
    v_mfma_f32_16x16x32_bf16 v[180:183], a[180:183], v[36:39], v[180:183]
    ds_read_b64_tr_b16 v[0:1], v247 offset:36864
    ds_read_b64_tr_b16 v[2:3], v247 offset:39936
    ds_read_b64_tr_b16 v[4:5], v248 offset:36864
    v_mfma_f32_16x16x32_bf16 v[184:187], a[184:187], v[36:39], v[184:187]
    ds_read_b64_tr_b16 v[6:7], v248 offset:39936
    ds_read_b64_tr_b16 v[8:9], v247 offset:36928
    ds_read_b64_tr_b16 v[10:11], v247 offset:40000
    v_mfma_f32_16x16x32_bf16 v[188:191], a[188:191], v[36:39], v[188:191]
    ds_read_b64_tr_b16 v[12:13], v247 offset:43008
    v_mfma_f32_16x16x32_bf16 v[180:183], a[192:195], v[40:43], v[180:183]
    ds_read_b64_tr_b16 v[14:15], v247 offset:46080
    s_waitcnt lgkmcnt(9)
    v_mfma_f32_16x16x32_bf16 v[184:187], a[196:199], v[40:43], v[184:187]
    ds_read_b64_tr_b16 v[16:17], v248 offset:43008
    v_mfma_f32_16x16x32_bf16 v[188:191], a[200:203], v[40:43], v[188:191]
    ds_read_b64_tr_b16 v[18:19], v248 offset:46080
    v_mfma_f32_16x16x32_bf16 v[180:183], a[204:207], v[44:47], v[180:183]
    ds_read_b64_tr_b16 v[20:21], v247 offset:43072
    v_mfma_f32_16x16x32_bf16 v[184:187], a[208:211], v[44:47], v[184:187]
    ds_read_b64_tr_b16 v[22:23], v247 offset:46144
    v_mfma_f32_16x16x32_bf16 v[188:191], a[212:215], v[44:47], v[188:191]
    ds_read_b64_tr_b16 v[24:25], v247 offset:49152
    v_mfma_f32_16x16x32_bf16 v[192:195], a[180:183], v[48:51], v[192:195]
    ds_read_b64_tr_b16 v[26:27], v247 offset:52224
    v_mfma_f32_16x16x32_bf16 v[196:199], a[184:187], v[48:51], v[196:199]
    ds_read_b64_tr_b16 v[28:29], v248 offset:49152
    v_mfma_f32_16x16x32_bf16 v[200:203], a[188:191], v[48:51], v[200:203]
    ds_read_b64_tr_b16 v[30:31], v248 offset:52224
    v_mfma_f32_16x16x32_bf16 v[192:195], a[192:195], v[52:55], v[192:195]
    ds_read_b64_tr_b16 v[32:33], v247 offset:49216
    v_mfma_f32_16x16x32_bf16 v[196:199], a[196:199], v[52:55], v[196:199]
    ds_read_b64_tr_b16 v[34:35], v247 offset:52288
    v_mfma_f32_16x16x32_bf16 v[200:203], a[200:203], v[52:55], v[200:203]
    ds_read_b128 v[232:235], v244 offset:6144
    v_mfma_f32_16x16x32_bf16 v[192:195], a[204:207], v[56:59], v[192:195]
    ds_read_b128 v[236:239], v244 offset:7168
    v_mfma_f32_16x16x32_bf16 v[196:199], a[208:211], v[56:59], v[196:199]
    ds_read_b128 a[252:255], v244 offset:8192
    v_mfma_f32_16x16x32_bf16 v[200:203], a[212:215], v[56:59], v[200:203]
    ds_read_b128 v[228:231], v244 offset:9216
    v_mfma_f32_16x16x32_bf16 v[204:207], a[180:183], v[60:63], v[204:207]
    v_mfma_f32_16x16x32_bf16 v[208:211], a[184:187], v[60:63], v[208:211]
    v_mfma_f32_16x16x32_bf16 v[212:215], a[188:191], v[60:63], v[212:215]
    v_mfma_f32_16x16x32_bf16 v[204:207], a[192:195], v[64:67], v[204:207]
    v_mfma_f32_16x16x32_bf16 v[208:211], a[196:199], v[64:67], v[208:211]
    v_mfma_f32_16x16x32_bf16 v[212:215], a[200:203], v[64:67], v[212:215]
    v_mfma_f32_16x16x32_bf16 v[204:207], a[204:207], v[68:71], v[204:207]
    v_mfma_f32_16x16x32_bf16 v[208:211], a[208:211], v[68:71], v[208:211]
    v_mfma_f32_16x16x32_bf16 v[212:215], a[212:215], v[68:71], v[212:215]
    s_waitcnt vmcnt(10)
    s_barrier
    s_waitcnt lgkmcnt(1)
    v_mfma_f32_16x16x32_bf16 v[180:183], a[216:219], v[232:235], v[180:183]
    v_add_u32 v247, 55296, v247
    v_add_u32 v248, 55296, v248
    ds_read_b64_tr_b16 v[36:37], v247 offset:0
    v_mfma_f32_16x16x32_bf16 v[184:187], a[220:223], v[232:235], v[184:187]
    ds_read_b64_tr_b16 v[38:39], v247 offset:3072
    s_mul_i32 s43, s37, 23296
    v_mfma_f32_16x16x32_bf16 v[188:191], a[224:227], v[232:235], v[188:191]
    ds_read_b64_tr_b16 v[40:41], v248 offset:0
    s_add_u32 s43, s43, 49152
    v_mfma_f32_16x16x32_bf16 v[180:183], a[228:231], v[236:239], v[180:183]
    ds_read_b128 v[232:235], v244 offset:10240
    s_mul_i32 s44, s38, 96
    v_mfma_f32_16x16x32_bf16 v[184:187], a[232:235], v[236:239], v[184:187]
    ds_read_b64_tr_b16 v[42:43], v248 offset:3072
    s_add_u32 s44, s44, s43
    v_mfma_f32_16x16x32_bf16 v[188:191], a[236:239], v[236:239], v[188:191]
    ds_read_b64_tr_b16 v[44:45], v247 offset:64
    s_mul_i32 s45, s38, 88
    v_mfma_f32_16x16x32_bf16 v[180:183], a[240:243], a[252:255], v[180:183]
    ds_read_b128 v[236:239], v244 offset:11264
    v_mbcnt_lo_u32_b32 v251, -1, 0
    v_mfma_f32_16x16x32_bf16 v[184:187], a[244:247], a[252:255], v[184:187]
    ds_read_b64_tr_b16 v[46:47], v247 offset:3136
    v_mbcnt_hi_u32_b32 v251, -1, v251
    v_mfma_f32_16x16x32_bf16 v[188:191], a[248:251], a[252:255], v[188:191]
    ds_read_b64_tr_b16 v[48:49], v247 offset:6144
    v_and_b32 v252, 15, v251
    s_waitcnt lgkmcnt(9)
    v_mfma_f32_16x16x32_bf16 v[192:195], a[216:219], v[228:231], v[192:195]
    ds_read_b128 a[252:255], v244 offset:6160
    ds_read_b64_tr_b16 v[50:51], v247 offset:9216
    v_mfma_f32_16x16x32_bf16 v[196:199], a[220:223], v[228:231], v[196:199]
    ds_read_b64_tr_b16 v[52:53], v248 offset:6144
    v_mul_u32_u24 v252, 208, v252
    v_mfma_f32_16x16x32_bf16 v[200:203], a[224:227], v[228:231], v[200:203]
    ds_read_b64_tr_b16 v[54:55], v248 offset:9216
    v_lshrrev_b32 v253, 4, v251
    s_waitcnt lgkmcnt(9)
    v_mfma_f32_16x16x32_bf16 v[192:195], a[228:231], v[232:235], v[192:195]
    ds_read_b128 v[228:231], v244 offset:7184
    v_lshl_add_u32 v253, v253, 3, v252
    v_mfma_f32_16x16x32_bf16 v[196:199], a[232:235], v[232:235], v[196:199]
    ds_read_b64_tr_b16 v[56:57], v247 offset:6208
    v_add_u32 v253, s44, v253
    v_mfma_f32_16x16x32_bf16 v[200:203], a[236:239], v[232:235], v[200:203]
    ds_read_b64_tr_b16 v[58:59], v247 offset:9280
    v_add_u32 v251, s45, v251
    s_waitcnt lgkmcnt(9)
    v_mfma_f32_16x16x32_bf16 v[192:195], a[240:243], v[236:239], v[192:195]
    ds_read_b128 v[232:235], v244 offset:8208
    v_mul_u32_u24 v252, 171, v251
    v_mfma_f32_16x16x32_bf16 v[196:199], a[244:247], v[236:239], v[196:199]
    ds_read_b64_tr_b16 v[60:61], v247 offset:12288
    v_lshrrev_b32 v252, 11, v252
    v_mfma_f32_16x16x32_bf16 v[200:203], a[248:251], v[236:239], v[200:203]
    ds_read_b64_tr_b16 v[62:63], v247 offset:15360
    v_add_lshl_u32 v254, v251, v252, 4
    s_waitcnt lgkmcnt(9)
    v_mfma_f32_16x16x32_bf16 v[180:183], v[0:3], a[252:255], v[180:183]
    ds_read_b128 v[236:239], v244 offset:9232
    ds_read_b64_tr_b16 v[64:65], v248 offset:12288
    v_mfma_f32_16x16x32_bf16 v[184:187], v[4:7], a[252:255], v[184:187]
    ds_read_b64_tr_b16 v[66:67], v248 offset:15360
    v_add_u32 v254, s43, v254
    v_mfma_f32_16x16x32_bf16 v[188:191], v[8:11], a[252:255], v[188:191]
    ds_read_b64_tr_b16 v[68:69], v247 offset:12352
    v_add_u32 v251, 64, v251
    s_waitcnt lgkmcnt(9)
    v_mfma_f32_16x16x32_bf16 v[180:183], v[12:15], v[228:231], v[180:183]
    ds_read_b128 a[252:255], v244 offset:10256
    v_mul_u32_u24 v252, 171, v251
    v_mfma_f32_16x16x32_bf16 v[184:187], v[16:19], v[228:231], v[184:187]
    ds_read_b64_tr_b16 v[70:71], v247 offset:15424
    v_lshrrev_b32 v252, 11, v252
    v_mfma_f32_16x16x32_bf16 v[188:191], v[20:23], v[228:231], v[188:191]
    v_add_u32 v243, s58, v240
    v_add_u32 v250, s61, v241
    s_waitcnt vmcnt(5)
    ds_read_b64 v[156:157], v250 offset:0
    s_waitcnt lgkmcnt(9)
    v_mfma_f32_16x16x32_bf16 v[180:183], v[24:27], v[232:235], v[180:183]
    ds_read_b128 v[228:231], v244 offset:11280
    ds_read_b128 v[168:171], v243 offset:0
    v_mfma_f32_16x16x32_bf16 v[184:187], v[28:31], v[232:235], v[184:187]
    ds_read_b128 v[172:175], v243 offset:64
    v_add_lshl_u32 v255, v251, v252, 4
    v_mfma_f32_16x16x32_bf16 v[188:191], v[32:35], v[232:235], v[188:191]
    ds_read_b128 v[176:179], v243 offset:128
    v_add_u32 v255, s43, v255
    s_waitcnt lgkmcnt(10)
    v_mfma_f32_16x16x32_bf16 v[192:195], v[0:3], v[236:239], v[192:195]
    ds_read_b128 v[232:235], v244 offset:6176
    v_mfma_f32_16x16x32_bf16 v[196:199], v[4:7], v[236:239], v[196:199]
    ds_read_b64 v[158:159], v250 offset:32
    v_mfma_f32_16x16x32_bf16 v[200:203], v[8:11], v[236:239], v[200:203]
    ds_read_b64 v[160:161], v250 offset:64
    s_waitcnt lgkmcnt(9)
    v_mfma_f32_16x16x32_bf16 v[192:195], v[12:15], a[252:255], v[192:195]
    ds_read_b128 v[236:239], v244 offset:7200
    s_waitcnt lgkmcnt(8)
    v_lshlrev_b32 v144, 16, v156
    v_mfma_f32_16x16x32_bf16 v[196:199], v[16:19], a[252:255], v[196:199]
    ds_read_b64 v[162:163], v250 offset:96
    v_and_b32 v145, 0xffff0000, v156
    v_mfma_f32_16x16x32_bf16 v[200:203], v[20:23], a[252:255], v[200:203]
    ds_read_b64 v[164:165], v250 offset:128
    v_lshlrev_b32 v146, 16, v157
    s_waitcnt lgkmcnt(9)
    v_mfma_f32_16x16x32_bf16 v[192:195], v[24:27], v[228:231], v[192:195]
    ds_read_b128 a[252:255], v244 offset:8224
    v_and_b32 v147, 0xffff0000, v157
    v_mfma_f32_16x16x32_bf16 v[196:199], v[28:31], v[228:231], v[196:199]
    ds_read_b64 v[166:167], v250 offset:160
    v_mfma_f32_16x16x32_bf16 v[200:203], v[32:35], v[228:231], v[200:203]
    s_waitcnt lgkmcnt(9)
    v_mfma_f32_16x16x32_bf16 v[144:147], v[72:75], v[168:171], v[144:147]
    ds_read_b128 v[228:231], v244 offset:9248
    s_waitcnt lgkmcnt(7)
    v_lshlrev_b32 v148, 16, v158
    v_and_b32 v149, 0xffff0000, v158
    v_lshlrev_b32 v150, 16, v159
    v_and_b32 v151, 0xffff0000, v159
    v_mfma_f32_16x16x32_bf16 v[144:147], v[96:99], v[172:175], v[144:147]
    s_waitcnt lgkmcnt(6)
    v_lshlrev_b32 v152, 16, v160
    v_and_b32 v153, 0xffff0000, v160
    v_mfma_f32_16x16x32_bf16 v[144:147], v[120:123], v[176:179], v[144:147]
    v_lshlrev_b32 v154, 16, v161
    v_and_b32 v155, 0xffff0000, v161
    v_mfma_f32_16x16x32_bf16 v[148:151], v[76:79], v[168:171], v[148:151]
    s_waitcnt lgkmcnt(4)
    v_lshlrev_b32 v156, 16, v162
    v_and_b32 v157, 0xffff0000, v162
    v_mfma_f32_16x16x32_bf16 v[148:151], v[100:103], v[172:175], v[148:151]
    v_lshlrev_b32 v158, 16, v163
    v_and_b32 v159, 0xffff0000, v163
    v_mfma_f32_16x16x32_bf16 v[148:151], v[124:127], v[176:179], v[148:151]
    s_waitcnt lgkmcnt(3)
    v_lshlrev_b32 v160, 16, v164
    v_and_b32 v161, 0xffff0000, v164
    v_mfma_f32_16x16x32_bf16 v[152:155], v[80:83], v[168:171], v[152:155]
    v_lshlrev_b32 v162, 16, v165
    v_and_b32 v163, 0xffff0000, v165
    v_mfma_f32_16x16x32_bf16 v[152:155], v[104:107], v[172:175], v[152:155]
    s_waitcnt lgkmcnt(1)
    v_lshlrev_b32 v164, 16, v166
    v_and_b32 v165, 0xffff0000, v166
    v_mfma_f32_16x16x32_bf16 v[152:155], v[128:131], v[176:179], v[152:155]
    v_lshlrev_b32 v166, 16, v167
    v_and_b32 v167, 0xffff0000, v167
    v_mfma_f32_16x16x32_bf16 v[156:159], v[84:87], v[168:171], v[156:159]
    v_add_u32 v243, s58, v242
    v_cvt_pk_bf16_f32 v144, v144, v145
    v_mfma_f32_16x16x32_bf16 v[156:159], v[108:111], v[172:175], v[156:159]
    v_cvt_pk_bf16_f32 v145, v146, v147
    v_cvt_pk_bf16_f32 v146, v148, v149
    v_mfma_f32_16x16x32_bf16 v[156:159], v[132:135], v[176:179], v[156:159]
    v_cvt_pk_bf16_f32 v147, v150, v151
    ds_write_b128 v243, v[144:147] offset:0
    v_mfma_f32_16x16x32_bf16 v[160:163], v[88:91], v[168:171], v[160:163]
    v_cvt_pk_bf16_f32 v148, v152, v153
    v_cvt_pk_bf16_f32 v149, v154, v155
    v_mfma_f32_16x16x32_bf16 v[160:163], v[112:115], v[172:175], v[160:163]
    s_nop 1
    v_cvt_pk_bf16_f32 v150, v156, v157
    v_mfma_f32_16x16x32_bf16 v[160:163], v[136:139], v[176:179], v[160:163]
    v_cvt_pk_bf16_f32 v151, v158, v159
    ds_write_b128 v243, v[148:151] offset:1024
    v_mfma_f32_16x16x32_bf16 v[164:167], v[92:95], v[168:171], v[164:167]
    s_nop 2
    v_mfma_f32_16x16x32_bf16 v[164:167], v[116:119], v[172:175], v[164:167]
    s_nop 0
    v_cvt_pk_bf16_f32 v152, v160, v161
    v_cvt_pk_bf16_f32 v153, v162, v163
    v_mfma_f32_16x16x32_bf16 v[164:167], v[140:143], v[176:179], v[164:167]
    s_nop 2
    v_mfma_f32_16x16x32_bf16 v[180:183], v[36:39], v[232:235], v[180:183]
    s_nop 2
    v_mfma_f32_16x16x32_bf16 v[184:187], v[40:43], v[232:235], v[184:187]
    v_cvt_pk_bf16_f32 v154, v164, v165
    v_cvt_pk_bf16_f32 v155, v166, v167
    v_mfma_f32_16x16x32_bf16 v[188:191], v[44:47], v[232:235], v[188:191]
    ds_write_b128 v243, v[152:155] offset:2048
    v_mfma_f32_16x16x32_bf16 v[180:183], v[48:51], v[236:239], v[180:183]
    ds_read_b128 v[232:235], v244 offset:10272
    v_mfma_f32_16x16x32_bf16 v[184:187], v[52:55], v[236:239], v[184:187]
    v_mfma_f32_16x16x32_bf16 v[188:191], v[56:59], v[236:239], v[188:191]
    v_mfma_f32_16x16x32_bf16 v[180:183], v[60:63], a[252:255], v[180:183]
    ds_read_b128 v[236:239], v244 offset:11296
    v_mfma_f32_16x16x32_bf16 v[184:187], v[64:67], a[252:255], v[184:187]
    v_mfma_f32_16x16x32_bf16 v[188:191], v[68:71], a[252:255], v[188:191]
    s_waitcnt lgkmcnt(2)
    s_barrier
    v_mfma_f32_16x16x32_bf16 v[192:195], v[36:39], v[228:231], v[192:195]
    s_nop 1
    v_cvt_pk_bf16_f32 v180, v180, v181
    v_mfma_f32_16x16x32_bf16 v[196:199], v[40:43], v[228:231], v[196:199]
    v_cvt_pk_bf16_f32 v181, v182, v183
    ds_write_b64 v253, v[180:181] offset:0
    v_mfma_f32_16x16x32_bf16 v[200:203], v[44:47], v[228:231], v[200:203]
    v_cvt_pk_bf16_f32 v182, v184, v185
    v_cvt_pk_bf16_f32 v183, v186, v187
    s_waitcnt lgkmcnt(2)
    v_mfma_f32_16x16x32_bf16 v[192:195], v[48:51], v[232:235], v[192:195]
    ds_read_b128 a[252:255], v244 offset:12288
    ds_write_b64 v253, v[182:183] offset:32
    v_mfma_f32_16x16x32_bf16 v[196:199], v[52:55], v[232:235], v[196:199]
    ds_read_b128 v[228:231], v244 offset:13312
    v_cvt_pk_bf16_f32 v184, v188, v189
    v_mfma_f32_16x16x32_bf16 v[200:203], v[56:59], v[232:235], v[200:203]
    v_cvt_pk_bf16_f32 v185, v190, v191
    ds_write_b64 v253, v[184:185] offset:64
    s_waitcnt lgkmcnt(5)
    v_mfma_f32_16x16x32_bf16 v[192:195], v[60:63], v[236:239], v[192:195]
    ds_read_b128 v[232:235], v244 offset:14336
    v_mfma_f32_16x16x32_bf16 v[196:199], v[64:67], v[236:239], v[196:199]
    v_mfma_f32_16x16x32_bf16 v[200:203], v[68:71], v[236:239], v[200:203]
    s_waitcnt lgkmcnt(4)
    v_mfma_f32_16x16x32_bf16 v[204:207], a[216:219], a[252:255], v[204:207]
    ds_read_b128 v[236:239], v244 offset:12304
    s_nop 0
    v_mfma_f32_16x16x32_bf16 v[208:211], a[220:223], a[252:255], v[208:211]
    v_cvt_pk_bf16_f32 v192, v192, v193
    v_cvt_pk_bf16_f32 v193, v194, v195
    v_mfma_f32_16x16x32_bf16 v[212:215], a[224:227], a[252:255], v[212:215]
    ds_write_b64 v253, v[192:193] offset:3328
    v_cvt_pk_bf16_f32 v194, v196, v197
    v_mfma_f32_16x16x32_bf16 v[216:219], a[108:111], a[252:255], v[216:219]
    v_cvt_pk_bf16_f32 v195, v198, v199
    ds_write_b64 v253, v[194:195] offset:3360
    v_mfma_f32_16x16x32_bf16 v[220:223], a[112:115], a[252:255], v[220:223]
    v_cvt_pk_bf16_f32 v196, v200, v201
    v_cvt_pk_bf16_f32 v197, v202, v203
    v_mfma_f32_16x16x32_bf16 v[224:227], a[116:119], a[252:255], v[224:227]
    ds_write_b64 v253, v[196:197] offset:3392
    s_waitcnt lgkmcnt(5)
    v_mfma_f32_16x16x32_bf16 v[204:207], a[228:231], v[228:231], v[204:207]
    v_mfma_f32_16x16x32_bf16 v[208:211], a[232:235], v[228:231], v[208:211]
    v_mfma_f32_16x16x32_bf16 v[212:215], a[236:239], v[228:231], v[212:215]
    v_mfma_f32_16x16x32_bf16 v[216:219], a[120:123], v[228:231], v[216:219]
    v_mfma_f32_16x16x32_bf16 v[220:223], a[124:127], v[228:231], v[220:223]
    v_mfma_f32_16x16x32_bf16 v[224:227], a[128:131], v[228:231], v[224:227]
    s_waitcnt lgkmcnt(3)
    v_mfma_f32_16x16x32_bf16 v[204:207], a[240:243], v[232:235], v[204:207]
    v_mfma_f32_16x16x32_bf16 v[208:211], a[244:247], v[232:235], v[208:211]
    v_mfma_f32_16x16x32_bf16 v[212:215], a[248:251], v[232:235], v[212:215]
    v_mfma_f32_16x16x32_bf16 v[216:219], a[132:135], v[232:235], v[216:219]
    v_mfma_f32_16x16x32_bf16 v[220:223], a[136:139], v[232:235], v[220:223]
    v_mfma_f32_16x16x32_bf16 v[224:227], a[140:143], v[232:235], v[224:227]
    v_mfma_f32_16x16x32_bf16 v[180:183], a[0:3], a[252:255], 0
    v_mfma_f32_16x16x32_bf16 v[184:187], a[4:7], a[252:255], 0
    v_mfma_f32_16x16x32_bf16 v[188:191], a[8:11], a[252:255], 0
    v_mfma_f32_16x16x32_bf16 v[180:183], a[12:15], v[228:231], v[180:183]
    ds_read_b128 a[252:255], v244 offset:13328
    v_mfma_f32_16x16x32_bf16 v[184:187], a[16:19], v[228:231], v[184:187]
    v_mfma_f32_16x16x32_bf16 v[188:191], a[20:23], v[228:231], v[188:191]
    v_mfma_f32_16x16x32_bf16 v[180:183], a[24:27], v[232:235], v[180:183]
    ds_read_b128 v[228:231], v244 offset:14352
    v_mfma_f32_16x16x32_bf16 v[184:187], a[28:31], v[232:235], v[184:187]
    v_mfma_f32_16x16x32_bf16 v[188:191], a[32:35], v[232:235], v[188:191]
    s_branch TOVER2
TSTUB2:
    s_branch TBACK2
TOVER2:
    v_mfma_f32_16x16x32_bf16 v[204:207], v[0:3], v[236:239], v[204:207]
    ds_read_b128 v[232:235], v244 offset:12320
    v_mfma_f32_16x16x32_bf16 v[208:211], v[4:7], v[236:239], v[208:211]
    v_mfma_f32_16x16x32_bf16 v[212:215], v[8:11], v[236:239], v[212:215]
    v_mfma_f32_16x16x32_bf16 v[216:219], a[144:147], v[236:239], v[216:219]
    v_mfma_f32_16x16x32_bf16 v[220:223], a[148:151], v[236:239], v[220:223]
    v_mfma_f32_16x16x32_bf16 v[224:227], a[152:155], v[236:239], v[224:227]
    v_mfma_f32_16x16x32_bf16 v[180:183], a[36:39], v[236:239], v[180:183]
    v_mfma_f32_16x16x32_bf16 v[184:187], a[40:43], v[236:239], v[184:187]
    v_mfma_f32_16x16x32_bf16 v[188:191], a[44:47], v[236:239], v[188:191]
    s_waitcnt lgkmcnt(1)
    v_mfma_f32_16x16x32_bf16 v[204:207], v[12:15], a[252:255], v[204:207]
    ds_read_b128 v[236:239], v244 offset:13344
    v_mfma_f32_16x16x32_bf16 v[208:211], v[16:19], a[252:255], v[208:211]
    v_mfma_f32_16x16x32_bf16 v[212:215], v[20:23], a[252:255], v[212:215]
    v_mfma_f32_16x16x32_bf16 v[216:219], a[156:159], a[252:255], v[216:219]
    v_mfma_f32_16x16x32_bf16 v[220:223], a[160:163], a[252:255], v[220:223]
    v_mfma_f32_16x16x32_bf16 v[224:227], a[164:167], a[252:255], v[224:227]
    v_mfma_f32_16x16x32_bf16 v[180:183], a[48:51], a[252:255], v[180:183]
    v_mfma_f32_16x16x32_bf16 v[184:187], a[52:55], a[252:255], v[184:187]
    v_mfma_f32_16x16x32_bf16 v[188:191], a[56:59], a[252:255], v[188:191]
    v_mfma_f32_16x16x32_bf16 v[204:207], v[24:27], v[228:231], v[204:207]
    ds_read_b128 a[252:255], v244 offset:14368
    v_mfma_f32_16x16x32_bf16 v[208:211], v[28:31], v[228:231], v[208:211]
    v_mfma_f32_16x16x32_bf16 v[212:215], v[32:35], v[228:231], v[212:215]
    v_mfma_f32_16x16x32_bf16 v[216:219], a[168:171], v[228:231], v[216:219]
    v_mfma_f32_16x16x32_bf16 v[220:223], a[172:175], v[228:231], v[220:223]
    v_mfma_f32_16x16x32_bf16 v[224:227], a[176:179], v[228:231], v[224:227]
    v_mfma_f32_16x16x32_bf16 v[180:183], a[60:63], v[228:231], v[180:183]
    v_mfma_f32_16x16x32_bf16 v[184:187], a[64:67], v[228:231], v[184:187]
    v_mfma_f32_16x16x32_bf16 v[188:191], a[68:71], v[228:231], v[188:191]
    s_waitcnt lgkmcnt(1)
    v_mfma_f32_16x16x32_bf16 v[204:207], v[36:39], v[232:235], v[204:207]
    ds_read_b128 v[228:231], v244 offset:15360
    v_mfma_f32_16x16x32_bf16 v[208:211], v[40:43], v[232:235], v[208:211]
    v_mfma_f32_16x16x32_bf16 v[212:215], v[44:47], v[232:235], v[212:215]
    v_mfma_f32_16x16x32_bf16 v[216:219], a[180:183], v[232:235], v[216:219]
    v_mfma_f32_16x16x32_bf16 v[220:223], a[184:187], v[232:235], v[220:223]
    v_mfma_f32_16x16x32_bf16 v[224:227], a[188:191], v[232:235], v[224:227]
    v_mfma_f32_16x16x32_bf16 v[180:183], a[72:75], v[232:235], v[180:183]
    v_mfma_f32_16x16x32_bf16 v[184:187], a[76:79], v[232:235], v[184:187]
    v_mfma_f32_16x16x32_bf16 v[188:191], a[80:83], v[232:235], v[188:191]
    v_mfma_f32_16x16x32_bf16 v[204:207], v[48:51], v[236:239], v[204:207]
    ds_read_b128 v[232:235], v244 offset:16384
    v_mfma_f32_16x16x32_bf16 v[208:211], v[52:55], v[236:239], v[208:211]
    v_mfma_f32_16x16x32_bf16 v[212:215], v[56:59], v[236:239], v[212:215]
    v_mfma_f32_16x16x32_bf16 v[216:219], a[192:195], v[236:239], v[216:219]
    v_mfma_f32_16x16x32_bf16 v[220:223], a[196:199], v[236:239], v[220:223]
    v_mfma_f32_16x16x32_bf16 v[224:227], a[200:203], v[236:239], v[224:227]
    v_mfma_f32_16x16x32_bf16 v[180:183], a[84:87], v[236:239], v[180:183]
    v_mfma_f32_16x16x32_bf16 v[184:187], a[88:91], v[236:239], v[184:187]
    v_mfma_f32_16x16x32_bf16 v[188:191], a[92:95], v[236:239], v[188:191]
    s_waitcnt lgkmcnt(1)
    v_mfma_f32_16x16x32_bf16 v[204:207], v[60:63], a[252:255], v[204:207]
    ds_read_b128 v[236:239], v244 offset:17408
    v_mfma_f32_16x16x32_bf16 v[208:211], v[64:67], a[252:255], v[208:211]
    v_mfma_f32_16x16x32_bf16 v[212:215], v[68:71], a[252:255], v[212:215]
    v_mfma_f32_16x16x32_bf16 v[216:219], a[204:207], a[252:255], v[216:219]
    v_mfma_f32_16x16x32_bf16 v[220:223], a[208:211], a[252:255], v[220:223]
    v_mfma_f32_16x16x32_bf16 v[224:227], a[212:215], a[252:255], v[224:227]
    v_mfma_f32_16x16x32_bf16 v[180:183], a[96:99], a[252:255], v[180:183]
    v_mfma_f32_16x16x32_bf16 v[184:187], a[100:103], a[252:255], v[184:187]
    v_mfma_f32_16x16x32_bf16 v[188:191], a[104:107], a[252:255], v[188:191]
    v_mfma_f32_16x16x32_bf16 v[216:219], a[216:219], v[228:231], v[216:219]
    ds_read_b128 a[252:255], v244 offset:15376
    v_add_u32 v243, s39, v240
    v_add_u32 v250, s6, v241
    s_waitcnt vmcnt(0)
    ds_read_b64 v[156:157], v250 offset:0
    ds_read_b128 v[168:171], v243 offset:0
    v_mfma_f32_16x16x32_bf16 v[220:223], a[220:223], v[228:231], v[220:223]
    ds_read_b128 v[172:175], v243 offset:64
    ds_read_b128 v[176:179], v243 offset:128
    v_mfma_f32_16x16x32_bf16 v[224:227], a[224:227], v[228:231], v[224:227]
    ds_read_b64 v[158:159], v250 offset:32
    v_cvt_pk_bf16_f32 v204, v204, v205
    v_mfma_f32_16x16x32_bf16 v[180:183], a[108:111], v[228:231], v[180:183]
    ds_read_b64 v[160:161], v250 offset:64
    v_cvt_pk_bf16_f32 v205, v206, v207
    v_mfma_f32_16x16x32_bf16 v[184:187], a[112:115], v[228:231], v[184:187]
    ds_read_b64 v[162:163], v250 offset:96
    ds_write_b64 v253, v[204:205] offset:6656
    v_mfma_f32_16x16x32_bf16 v[188:191], a[116:119], v[228:231], v[188:191]
    ds_read_b64 v[164:165], v250 offset:128
    v_cvt_pk_bf16_f32 v206, v208, v209
    v_mfma_f32_16x16x32_bf16 v[192:195], a[0:3], v[228:231], 0
    ds_read_b64 v[166:167], v250 offset:160
    v_cvt_pk_bf16_f32 v207, v210, v211
    v_mfma_f32_16x16x32_bf16 v[196:199], a[4:7], v[228:231], 0
    ds_write_b64 v253, v[206:207] offset:6688
    v_cvt_pk_bf16_f32 v208, v212, v213
    v_mfma_f32_16x16x32_bf16 v[200:203], a[8:11], v[228:231], 0
    v_cvt_pk_bf16_f32 v209, v214, v215
    ds_write_b64 v253, v[208:209] offset:6720
    s_waitcnt lgkmcnt(12)
    v_mfma_f32_16x16x32_bf16 v[216:219], a[228:231], v[232:235], v[216:219]
    ds_read_b128 v[228:231], v244 offset:16400
    s_waitcnt lgkmcnt(12)
    v_lshlrev_b32 v144, 16, v156
    v_mfma_f32_16x16x32_bf16 v[220:223], a[232:235], v[232:235], v[220:223]
    v_and_b32 v145, 0xffff0000, v156
    v_lshlrev_b32 v146, 16, v157
    v_mfma_f32_16x16x32_bf16 v[224:227], a[236:239], v[232:235], v[224:227]
    v_and_b32 v147, 0xffff0000, v157
    s_waitcnt lgkmcnt(8)
    v_lshlrev_b32 v148, 16, v158
    v_mfma_f32_16x16x32_bf16 v[180:183], a[120:123], v[232:235], v[180:183]
    v_and_b32 v149, 0xffff0000, v158
    v_lshlrev_b32 v150, 16, v159
    v_mfma_f32_16x16x32_bf16 v[184:187], a[124:127], v[232:235], v[184:187]
    v_and_b32 v151, 0xffff0000, v159
    s_waitcnt lgkmcnt(6)
    v_lshlrev_b32 v152, 16, v160
    v_mfma_f32_16x16x32_bf16 v[188:191], a[128:131], v[232:235], v[188:191]
    v_and_b32 v153, 0xffff0000, v160
    v_lshlrev_b32 v154, 16, v161
    v_mfma_f32_16x16x32_bf16 v[192:195], a[12:15], v[232:235], v[192:195]
    v_and_b32 v155, 0xffff0000, v161
    v_lshlrev_b32 v156, 16, v162
    v_mfma_f32_16x16x32_bf16 v[196:199], a[16:19], v[232:235], v[196:199]
    v_and_b32 v157, 0xffff0000, v162
    v_lshlrev_b32 v158, 16, v163
    v_mfma_f32_16x16x32_bf16 v[200:203], a[20:23], v[232:235], v[200:203]
    v_and_b32 v159, 0xffff0000, v163
    s_waitcnt lgkmcnt(2)
    v_lshlrev_b32 v160, 16, v164
    v_mfma_f32_16x16x32_bf16 v[216:219], a[240:243], v[236:239], v[216:219]
    ds_read_b128 v[232:235], v244 offset:17424
    v_and_b32 v161, 0xffff0000, v164
    v_mfma_f32_16x16x32_bf16 v[220:223], a[244:247], v[236:239], v[220:223]
    v_lshlrev_b32 v162, 16, v165
    v_and_b32 v163, 0xffff0000, v165
    v_mfma_f32_16x16x32_bf16 v[224:227], a[248:251], v[236:239], v[224:227]
    v_lshlrev_b32 v164, 16, v166
    v_and_b32 v165, 0xffff0000, v166
    v_mfma_f32_16x16x32_bf16 v[180:183], a[132:135], v[236:239], v[180:183]
    v_lshlrev_b32 v166, 16, v167
    v_and_b32 v167, 0xffff0000, v167
    v_mfma_f32_16x16x32_bf16 v[184:187], a[136:139], v[236:239], v[184:187]
    v_mfma_f32_16x16x32_bf16 v[188:191], a[140:143], v[236:239], v[188:191]
    v_mfma_f32_16x16x32_bf16 v[192:195], a[24:27], v[236:239], v[192:195]
    v_mfma_f32_16x16x32_bf16 v[196:199], a[28:31], v[236:239], v[196:199]
    v_mfma_f32_16x16x32_bf16 v[200:203], a[32:35], v[236:239], v[200:203]
    v_mfma_f32_16x16x32_bf16 v[144:147], v[72:75], v[168:171], v[144:147]
    ds_read_b128 v[236:239], v244 offset:15392
    v_mfma_f32_16x16x32_bf16 v[144:147], v[96:99], v[172:175], v[144:147]
    v_mfma_f32_16x16x32_bf16 v[144:147], v[120:123], v[176:179], v[144:147]
    v_add_u32 v243, s61, v242
    s_nop 0
    v_mfma_f32_16x16x32_bf16 v[148:151], v[76:79], v[168:171], v[148:151]
    s_nop 2
    v_mfma_f32_16x16x32_bf16 v[148:151], v[100:103], v[172:175], v[148:151]
    s_nop 0
    v_cvt_pk_bf16_f32 v144, v144, v145
    v_cvt_pk_bf16_f32 v145, v146, v147
    v_mfma_f32_16x16x32_bf16 v[148:151], v[124:127], v[176:179], v[148:151]
    s_nop 2
    v_mfma_f32_16x16x32_bf16 v[152:155], v[80:83], v[168:171], v[152:155]
    s_nop 2
    v_mfma_f32_16x16x32_bf16 v[152:155], v[104:107], v[172:175], v[152:155]
    v_cvt_pk_bf16_f32 v146, v148, v149
    v_cvt_pk_bf16_f32 v147, v150, v151
    v_mfma_f32_16x16x32_bf16 v[152:155], v[128:131], v[176:179], v[152:155]
    ds_write_b128 v243, v[144:147] offset:0
    s_nop 0
    v_mfma_f32_16x16x32_bf16 v[156:159], v[84:87], v[168:171], v[156:159]
    s_nop 2
    v_mfma_f32_16x16x32_bf16 v[156:159], v[108:111], v[172:175], v[156:159]
    s_nop 0
    v_cvt_pk_bf16_f32 v148, v152, v153
    v_cvt_pk_bf16_f32 v149, v154, v155
    v_mfma_f32_16x16x32_bf16 v[156:159], v[132:135], v[176:179], v[156:159]
    s_nop 2
    v_mfma_f32_16x16x32_bf16 v[160:163], v[88:91], v[168:171], v[160:163]
    s_nop 2
    v_mfma_f32_16x16x32_bf16 v[160:163], v[112:115], v[172:175], v[160:163]
    v_cvt_pk_bf16_f32 v150, v156, v157
    v_cvt_pk_bf16_f32 v151, v158, v159
    v_mfma_f32_16x16x32_bf16 v[160:163], v[136:139], v[176:179], v[160:163]
    ds_write_b128 v243, v[148:151] offset:1024
    s_nop 0
    v_mfma_f32_16x16x32_bf16 v[164:167], v[92:95], v[168:171], v[164:167]
    s_nop 2
    v_mfma_f32_16x16x32_bf16 v[164:167], v[116:119], v[172:175], v[164:167]
    s_nop 0
    v_cvt_pk_bf16_f32 v152, v160, v161
    v_cvt_pk_bf16_f32 v153, v162, v163
    v_mfma_f32_16x16x32_bf16 v[164:167], v[140:143], v[176:179], v[164:167]
    s_nop 2
    v_mfma_f32_16x16x32_bf16 v[216:219], v[0:3], a[252:255], v[216:219]
    s_nop 2
    v_mfma_f32_16x16x32_bf16 v[220:223], v[4:7], a[252:255], v[220:223]
    v_cvt_pk_bf16_f32 v154, v164, v165
    v_cvt_pk_bf16_f32 v155, v166, v167
    v_mfma_f32_16x16x32_bf16 v[224:227], v[8:11], a[252:255], v[224:227]
    ds_write_b128 v243, v[152:155] offset:2048
    v_mfma_f32_16x16x32_bf16 v[180:183], a[144:147], a[252:255], v[180:183]
    v_mfma_f32_16x16x32_bf16 v[184:187], a[148:151], a[252:255], v[184:187]
    v_mfma_f32_16x16x32_bf16 v[188:191], a[152:155], a[252:255], v[188:191]
    v_mfma_f32_16x16x32_bf16 v[192:195], a[36:39], a[252:255], v[192:195]
    v_mfma_f32_16x16x32_bf16 v[196:199], a[40:43], a[252:255], v[196:199]
    v_mfma_f32_16x16x32_bf16 v[200:203], a[44:47], a[252:255], v[200:203]
    s_waitcnt lgkmcnt(1)
    v_mfma_f32_16x16x32_bf16 v[216:219], v[12:15], v[228:231], v[216:219]
    ds_read_b128 a[252:255], v244 offset:16416
    v_mfma_f32_16x16x32_bf16 v[220:223], v[16:19], v[228:231], v[220:223]
    v_mfma_f32_16x16x32_bf16 v[224:227], v[20:23], v[228:231], v[224:227]
    v_mfma_f32_16x16x32_bf16 v[180:183], a[156:159], v[228:231], v[180:183]
    s_waitcnt lgkmcnt(1)
    s_barrier
    ds_read_b128 v[204:207], v254 offset:0
    v_mfma_f32_16x16x32_bf16 v[184:187], a[160:163], v[228:231], v[184:187]
    ds_read_b128 v[208:211], v255 offset:0
    v_mfma_f32_16x16x32_bf16 v[188:191], a[164:167], v[228:231], v[188:191]
    v_mfma_f32_16x16x32_bf16 v[192:195], a[48:51], v[228:231], v[192:195]
    v_mfma_f32_16x16x32_bf16 v[196:199], a[52:55], v[228:231], v[196:199]
    v_mfma_f32_16x16x32_bf16 v[200:203], a[56:59], v[228:231], v[200:203]
    v_mfma_f32_16x16x32_bf16 v[216:219], v[24:27], v[232:235], v[216:219]
    ds_read_b128 v[228:231], v244 offset:17440
    v_mfma_f32_16x16x32_bf16 v[220:223], v[28:31], v[232:235], v[220:223]
    v_mfma_f32_16x16x32_bf16 v[224:227], v[32:35], v[232:235], v[224:227]
    v_mfma_f32_16x16x32_bf16 v[180:183], a[168:171], v[232:235], v[180:183]
    s_add_u32 s49, s48, 0
    s_waitcnt lgkmcnt(2)
    buffer_store_dwordx4 v[204:207], v245, s[32:35], s49 offen sc0 sc1
    v_mfma_f32_16x16x32_bf16 v[184:187], a[172:175], v[232:235], v[184:187]
    v_mfma_f32_16x16x32_bf16 v[188:191], a[176:179], v[232:235], v[188:191]
    v_mfma_f32_16x16x32_bf16 v[192:195], a[60:63], v[232:235], v[192:195]
    v_mfma_f32_16x16x32_bf16 v[196:199], a[64:67], v[232:235], v[196:199]
    v_mfma_f32_16x16x32_bf16 v[200:203], a[68:71], v[232:235], v[200:203]
    v_mfma_f32_16x16x32_bf16 v[216:219], v[36:39], v[236:239], v[216:219]
    ds_read_b128 v[232:235], v244 offset:18432
    v_mfma_f32_16x16x32_bf16 v[220:223], v[40:43], v[236:239], v[220:223]
    s_waitcnt lgkmcnt(1)
    buffer_store_dwordx4 v[208:211], v246, s[32:35], s49 offen offset:64 sc0 sc1
    v_mfma_f32_16x16x32_bf16 v[224:227], v[44:47], v[236:239], v[224:227]
    ds_read_b128 v[204:207], v254 offset:3328
    ds_read_b128 v[208:211], v255 offset:3328
    v_mfma_f32_16x16x32_bf16 v[180:183], a[180:183], v[236:239], v[180:183]
    v_mfma_f32_16x16x32_bf16 v[184:187], a[184:187], v[236:239], v[184:187]
    v_mfma_f32_16x16x32_bf16 v[188:191], a[188:191], v[236:239], v[188:191]
    v_mfma_f32_16x16x32_bf16 v[192:195], a[72:75], v[236:239], v[192:195]
    v_mfma_f32_16x16x32_bf16 v[196:199], a[76:79], v[236:239], v[196:199]
    v_mfma_f32_16x16x32_bf16 v[200:203], a[80:83], v[236:239], v[200:203]
    v_mfma_f32_16x16x32_bf16 v[216:219], v[48:51], a[252:255], v[216:219]
    ds_read_b128 v[236:239], v244 offset:19456
    v_mfma_f32_16x16x32_bf16 v[220:223], v[52:55], a[252:255], v[220:223]
    s_add_u32 s49, s48, 43008
    s_waitcnt lgkmcnt(2)
    buffer_store_dwordx4 v[204:207], v245, s[32:35], s49 offen sc0 sc1
    v_mfma_f32_16x16x32_bf16 v[224:227], v[56:59], a[252:255], v[224:227]
    v_mfma_f32_16x16x32_bf16 v[180:183], a[192:195], a[252:255], v[180:183]
    v_mfma_f32_16x16x32_bf16 v[184:187], a[196:199], a[252:255], v[184:187]
    v_mfma_f32_16x16x32_bf16 v[188:191], a[200:203], a[252:255], v[188:191]
    v_mfma_f32_16x16x32_bf16 v[192:195], a[84:87], a[252:255], v[192:195]
    v_mfma_f32_16x16x32_bf16 v[196:199], a[88:91], a[252:255], v[196:199]
    v_mfma_f32_16x16x32_bf16 v[200:203], a[92:95], a[252:255], v[200:203]
    s_waitcnt lgkmcnt(1)
    buffer_store_dwordx4 v[208:211], v246, s[32:35], s49 offen offset:64 sc0 sc1
    v_mfma_f32_16x16x32_bf16 v[216:219], v[60:63], v[228:231], v[216:219]
    ds_read_b128 a[252:255], v244 offset:20480
    ds_read_b128 v[204:207], v254 offset:6656
    v_mfma_f32_16x16x32_bf16 v[220:223], v[64:67], v[228:231], v[220:223]
    ds_read_b128 v[208:211], v255 offset:6656
    v_mfma_f32_16x16x32_bf16 v[224:227], v[68:71], v[228:231], v[224:227]
    v_mfma_f32_16x16x32_bf16 v[180:183], a[204:207], v[228:231], v[180:183]
    v_mfma_f32_16x16x32_bf16 v[184:187], a[208:211], v[228:231], v[184:187]
    v_mfma_f32_16x16x32_bf16 v[188:191], a[212:215], v[228:231], v[188:191]
    v_mfma_f32_16x16x32_bf16 v[192:195], a[96:99], v[228:231], v[192:195]
    v_mfma_f32_16x16x32_bf16 v[196:199], a[100:103], v[228:231], v[196:199]
    v_mfma_f32_16x16x32_bf16 v[200:203], a[104:107], v[228:231], v[200:203]
    v_mfma_f32_16x16x32_bf16 v[180:183], a[216:219], v[232:235], v[180:183]
    ds_read_b128 v[228:231], v244 offset:18448
    v_mfma_f32_16x16x32_bf16 v[184:187], a[220:223], v[232:235], v[184:187]
    s_add_u32 s49, s48, 86016
    s_waitcnt lgkmcnt(2)
    buffer_store_dwordx4 v[204:207], v245, s[32:35], s49 offen sc0 sc1
    v_mfma_f32_16x16x32_bf16 v[188:191], a[224:227], v[232:235], v[188:191]
    v_mfma_f32_16x16x32_bf16 v[192:195], a[108:111], v[232:235], v[192:195]
    v_mfma_f32_16x16x32_bf16 v[196:199], a[112:115], v[232:235], v[196:199]
    v_mfma_f32_16x16x32_bf16 v[200:203], a[116:119], v[232:235], v[200:203]
    s_waitcnt lgkmcnt(1)
    buffer_store_dwordx4 v[208:211], v246, s[32:35], s49 offen offset:64 sc0 sc1
    v_mfma_f32_16x16x32_bf16 v[204:207], a[0:3], v[232:235], 0
    v_cvt_pk_bf16_f32 v216, v216, v217
    v_cvt_pk_bf16_f32 v217, v218, v219
    v_mfma_f32_16x16x32_bf16 v[208:211], a[4:7], v[232:235], 0
    ds_write_b64 v253, v[216:217] offset:9984
    v_cvt_pk_bf16_f32 v218, v220, v221
    v_mfma_f32_16x16x32_bf16 v[212:215], a[8:11], v[232:235], 0
    v_cvt_pk_bf16_f32 v219, v222, v223
    ds_write_b64 v253, v[218:219] offset:10016
    v_mfma_f32_16x16x32_bf16 v[180:183], a[228:231], v[236:239], v[180:183]
    ds_read_b128 v[232:235], v244 offset:19472
    v_cvt_pk_bf16_f32 v220, v224, v225
    v_mfma_f32_16x16x32_bf16 v[184:187], a[232:235], v[236:239], v[184:187]
    v_cvt_pk_bf16_f32 v221, v226, v227
    ds_write_b64 v253, v[220:221] offset:10048
    v_mfma_f32_16x16x32_bf16 v[188:191], a[236:239], v[236:239], v[188:191]
    v_mfma_f32_16x16x32_bf16 v[192:195], a[120:123], v[236:239], v[192:195]
    v_mfma_f32_16x16x32_bf16 v[196:199], a[124:127], v[236:239], v[196:199]
    v_mfma_f32_16x16x32_bf16 v[200:203], a[128:131], v[236:239], v[200:203]
    v_mfma_f32_16x16x32_bf16 v[204:207], a[12:15], v[236:239], v[204:207]
    v_mfma_f32_16x16x32_bf16 v[208:211], a[16:19], v[236:239], v[208:211]
    v_mfma_f32_16x16x32_bf16 v[212:215], a[20:23], v[236:239], v[212:215]
    v_mfma_f32_16x16x32_bf16 v[180:183], a[240:243], a[252:255], v[180:183]
    ds_read_b128 v[236:239], v244 offset:20496
    v_mfma_f32_16x16x32_bf16 v[184:187], a[244:247], a[252:255], v[184:187]
    v_mfma_f32_16x16x32_bf16 v[188:191], a[248:251], a[252:255], v[188:191]
    v_mfma_f32_16x16x32_bf16 v[192:195], a[132:135], a[252:255], v[192:195]
    v_mfma_f32_16x16x32_bf16 v[196:199], a[136:139], a[252:255], v[196:199]
    v_mfma_f32_16x16x32_bf16 v[200:203], a[140:143], a[252:255], v[200:203]
    v_mfma_f32_16x16x32_bf16 v[204:207], a[24:27], a[252:255], v[204:207]
    v_mfma_f32_16x16x32_bf16 v[208:211], a[28:31], a[252:255], v[208:211]
    v_mfma_f32_16x16x32_bf16 v[212:215], a[32:35], a[252:255], v[212:215]
    s_waitcnt lgkmcnt(1)
    v_mfma_f32_16x16x32_bf16 v[180:183], v[0:3], v[228:231], v[180:183]
    ds_read_b128 a[252:255], v244 offset:18464
    v_mfma_f32_16x16x32_bf16 v[184:187], v[4:7], v[228:231], v[184:187]
    v_mfma_f32_16x16x32_bf16 v[188:191], v[8:11], v[228:231], v[188:191]
    v_mfma_f32_16x16x32_bf16 v[192:195], a[144:147], v[228:231], v[192:195]
    v_mfma_f32_16x16x32_bf16 v[196:199], a[148:151], v[228:231], v[196:199]
    v_mfma_f32_16x16x32_bf16 v[200:203], a[152:155], v[228:231], v[200:203]
    v_mfma_f32_16x16x32_bf16 v[204:207], a[36:39], v[228:231], v[204:207]
    v_mfma_f32_16x16x32_bf16 v[208:211], a[40:43], v[228:231], v[208:211]
    v_mfma_f32_16x16x32_bf16 v[212:215], a[44:47], v[228:231], v[212:215]
    v_mfma_f32_16x16x32_bf16 v[180:183], v[12:15], v[232:235], v[180:183]
    ds_read_b128 v[228:231], v244 offset:19488
    v_mfma_f32_16x16x32_bf16 v[184:187], v[16:19], v[232:235], v[184:187]
    v_mfma_f32_16x16x32_bf16 v[188:191], v[20:23], v[232:235], v[188:191]
    v_mfma_f32_16x16x32_bf16 v[192:195], a[156:159], v[232:235], v[192:195]
    v_mfma_f32_16x16x32_bf16 v[196:199], a[160:163], v[232:235], v[196:199]
    v_mfma_f32_16x16x32_bf16 v[200:203], a[164:167], v[232:235], v[200:203]
    v_mfma_f32_16x16x32_bf16 v[204:207], a[48:51], v[232:235], v[204:207]
    v_mfma_f32_16x16x32_bf16 v[208:211], a[52:55], v[232:235], v[208:211]
    v_mfma_f32_16x16x32_bf16 v[212:215], a[56:59], v[232:235], v[212:215]
    s_waitcnt lgkmcnt(1)
    v_mfma_f32_16x16x32_bf16 v[180:183], v[24:27], v[236:239], v[180:183]
    ds_read_b128 v[232:235], v244 offset:20512
    v_mfma_f32_16x16x32_bf16 v[184:187], v[28:31], v[236:239], v[184:187]
    v_mfma_f32_16x16x32_bf16 v[188:191], v[32:35], v[236:239], v[188:191]
    v_mfma_f32_16x16x32_bf16 v[192:195], a[168:171], v[236:239], v[192:195]
    v_mfma_f32_16x16x32_bf16 v[196:199], a[172:175], v[236:239], v[196:199]
    v_mfma_f32_16x16x32_bf16 v[200:203], a[176:179], v[236:239], v[200:203]
    v_mfma_f32_16x16x32_bf16 v[204:207], a[60:63], v[236:239], v[204:207]
    v_mfma_f32_16x16x32_bf16 v[208:211], a[64:67], v[236:239], v[208:211]
    v_mfma_f32_16x16x32_bf16 v[212:215], a[68:71], v[236:239], v[212:215]
    v_mfma_f32_16x16x32_bf16 v[180:183], v[36:39], a[252:255], v[180:183]
    ds_read_b128 v[236:239], v244 offset:21504
    v_mfma_f32_16x16x32_bf16 v[184:187], v[40:43], a[252:255], v[184:187]
    v_mfma_f32_16x16x32_bf16 v[188:191], v[44:47], a[252:255], v[188:191]
    v_mfma_f32_16x16x32_bf16 v[192:195], a[180:183], a[252:255], v[192:195]
    v_mfma_f32_16x16x32_bf16 v[196:199], a[184:187], a[252:255], v[196:199]
    v_mfma_f32_16x16x32_bf16 v[200:203], a[188:191], a[252:255], v[200:203]
    v_mfma_f32_16x16x32_bf16 v[204:207], a[72:75], a[252:255], v[204:207]
    v_mfma_f32_16x16x32_bf16 v[208:211], a[76:79], a[252:255], v[208:211]
    v_mfma_f32_16x16x32_bf16 v[212:215], a[80:83], a[252:255], v[212:215]
    s_waitcnt lgkmcnt(1)
    v_mfma_f32_16x16x32_bf16 v[180:183], v[48:51], v[228:231], v[180:183]
    ds_read_b128 a[252:255], v244 offset:22528
    v_mfma_f32_16x16x32_bf16 v[184:187], v[52:55], v[228:231], v[184:187]
    v_mfma_f32_16x16x32_bf16 v[188:191], v[56:59], v[228:231], v[188:191]
    v_mfma_f32_16x16x32_bf16 v[192:195], a[192:195], v[228:231], v[192:195]
    v_mfma_f32_16x16x32_bf16 v[196:199], a[196:199], v[228:231], v[196:199]
    v_mfma_f32_16x16x32_bf16 v[200:203], a[200:203], v[228:231], v[200:203]
    v_mfma_f32_16x16x32_bf16 v[204:207], a[84:87], v[228:231], v[204:207]
    v_mfma_f32_16x16x32_bf16 v[208:211], a[88:91], v[228:231], v[208:211]
    v_mfma_f32_16x16x32_bf16 v[212:215], a[92:95], v[228:231], v[212:215]
    v_mfma_f32_16x16x32_bf16 v[180:183], v[60:63], v[232:235], v[180:183]
    ds_read_b128 v[228:231], v244 offset:23552
    v_mfma_f32_16x16x32_bf16 v[184:187], v[64:67], v[232:235], v[184:187]
    v_mfma_f32_16x16x32_bf16 v[188:191], v[68:71], v[232:235], v[188:191]
    v_mfma_f32_16x16x32_bf16 v[192:195], a[204:207], v[232:235], v[192:195]
    v_mfma_f32_16x16x32_bf16 v[196:199], a[208:211], v[232:235], v[196:199]
    v_mfma_f32_16x16x32_bf16 v[200:203], a[212:215], v[232:235], v[200:203]
    v_mfma_f32_16x16x32_bf16 v[204:207], a[96:99], v[232:235], v[204:207]
    v_mfma_f32_16x16x32_bf16 v[208:211], a[100:103], v[232:235], v[208:211]
    v_mfma_f32_16x16x32_bf16 v[212:215], a[104:107], v[232:235], v[212:215]
    s_waitcnt lgkmcnt(1)
    v_mfma_f32_16x16x32_bf16 v[192:195], a[216:219], v[236:239], v[192:195]
    ds_read_b128 v[232:235], v244 offset:21520
    v_cvt_pk_bf16_f32 v180, v180, v181
    v_mfma_f32_16x16x32_bf16 v[196:199], a[220:223], v[236:239], v[196:199]
    v_cvt_pk_bf16_f32 v181, v182, v183
    ds_write_b64 v253, v[180:181] offset:13312
    v_mfma_f32_16x16x32_bf16 v[200:203], a[224:227], v[236:239], v[200:203]
    v_cvt_pk_bf16_f32 v182, v184, v185
    v_cvt_pk_bf16_f32 v183, v186, v187
    v_mfma_f32_16x16x32_bf16 v[204:207], a[108:111], v[236:239], v[204:207]
    ds_write_b64 v253, v[182:183] offset:13344
    v_cvt_pk_bf16_f32 v184, v188, v189
    v_mfma_f32_16x16x32_bf16 v[208:211], a[112:115], v[236:239], v[208:211]
    v_cvt_pk_bf16_f32 v185, v190, v191
    ds_write_b64 v253, v[184:185] offset:13376
    v_mfma_f32_16x16x32_bf16 v[212:215], a[116:119], v[236:239], v[212:215]
    v_mfma_f32_16x16x32_bf16 v[192:195], a[228:231], a[252:255], v[192:195]
    ds_read_b128 v[236:239], v244 offset:22544
    v_mfma_f32_16x16x32_bf16 v[196:199], a[232:235], a[252:255], v[196:199]
    v_mfma_f32_16x16x32_bf16 v[200:203], a[236:239], a[252:255], v[200:203]
    v_mfma_f32_16x16x32_bf16 v[204:207], a[120:123], a[252:255], v[204:207]
    v_mfma_f32_16x16x32_bf16 v[208:211], a[124:127], a[252:255], v[208:211]
    v_mfma_f32_16x16x32_bf16 v[212:215], a[128:131], a[252:255], v[212:215]
    s_waitcnt lgkmcnt(4)
    v_mfma_f32_16x16x32_bf16 v[192:195], a[240:243], v[228:231], v[192:195]
    ds_read_b128 a[252:255], v244 offset:23568
    v_mfma_f32_16x16x32_bf16 v[196:199], a[244:247], v[228:231], v[196:199]
    v_mfma_f32_16x16x32_bf16 v[200:203], a[248:251], v[228:231], v[200:203]
    v_mfma_f32_16x16x32_bf16 v[204:207], a[132:135], v[228:231], v[204:207]
    s_waitcnt lgkmcnt(2)
    s_barrier
    ds_read_b128 v[180:183], v254 offset:9984
    v_mfma_f32_16x16x32_bf16 v[208:211], a[136:139], v[228:231], v[208:211]
    ds_read_b128 v[184:187], v255 offset:9984
    v_mfma_f32_16x16x32_bf16 v[212:215], a[140:143], v[228:231], v[212:215]
    v_mfma_f32_16x16x32_bf16 v[192:195], v[0:3], v[232:235], v[192:195]
    ds_read_b128 v[228:231], v244 offset:21536
    v_mfma_f32_16x16x32_bf16 v[196:199], v[4:7], v[232:235], v[196:199]
    v_mfma_f32_16x16x32_bf16 v[200:203], v[8:11], v[232:235], v[200:203]
    v_mfma_f32_16x16x32_bf16 v[204:207], a[144:147], v[232:235], v[204:207]
    v_mfma_f32_16x16x32_bf16 v[208:211], a[148:151], v[232:235], v[208:211]
    v_mfma_f32_16x16x32_bf16 v[212:215], a[152:155], v[232:235], v[212:215]
    s_waitcnt lgkmcnt(3)
    v_mfma_f32_16x16x32_bf16 v[192:195], v[12:15], v[236:239], v[192:195]
    ds_read_b128 v[232:235], v244 offset:22560
    v_mfma_f32_16x16x32_bf16 v[196:199], v[16:19], v[236:239], v[196:199]
    s_add_u32 s49, s48, 129024
    s_waitcnt lgkmcnt(3)
    buffer_store_dwordx4 v[180:183], v245, s[32:35], s49 offen sc0 sc1
    v_mfma_f32_16x16x32_bf16 v[200:203], v[20:23], v[236:239], v[200:203]
    v_mfma_f32_16x16x32_bf16 v[204:207], a[156:159], v[236:239], v[204:207]
    v_mfma_f32_16x16x32_bf16 v[208:211], a[160:163], v[236:239], v[208:211]
    v_mfma_f32_16x16x32_bf16 v[212:215], a[164:167], v[236:239], v[212:215]
    v_mfma_f32_16x16x32_bf16 v[192:195], v[24:27], a[252:255], v[192:195]
    ds_read_b128 v[236:239], v244 offset:23584
    v_mfma_f32_16x16x32_bf16 v[196:199], v[28:31], a[252:255], v[196:199]
    v_mfma_f32_16x16x32_bf16 v[200:203], v[32:35], a[252:255], v[200:203]
    s_waitcnt lgkmcnt(2)
    buffer_store_dwordx4 v[184:187], v246, s[32:35], s49 offen offset:64 sc0 sc1
    v_mfma_f32_16x16x32_bf16 v[204:207], a[168:171], a[252:255], v[204:207]
    ds_read_b128 v[180:183], v254 offset:13312
    ds_read_b128 v[184:187], v255 offset:13312
    v_mfma_f32_16x16x32_bf16 v[208:211], a[172:175], a[252:255], v[208:211]
    v_mfma_f32_16x16x32_bf16 v[212:215], a[176:179], a[252:255], v[212:215]
    v_mfma_f32_16x16x32_bf16 v[192:195], v[36:39], v[228:231], v[192:195]
    ds_read_b128 a[252:255], v244 offset:24576
    v_mfma_f32_16x16x32_bf16 v[196:199], v[40:43], v[228:231], v[196:199]
    v_mfma_f32_16x16x32_bf16 v[200:203], v[44:47], v[228:231], v[200:203]
    v_mfma_f32_16x16x32_bf16 v[204:207], a[180:183], v[228:231], v[204:207]
    v_mfma_f32_16x16x32_bf16 v[208:211], a[184:187], v[228:231], v[208:211]
    v_mfma_f32_16x16x32_bf16 v[212:215], a[188:191], v[228:231], v[212:215]
    s_add_u32 s49, s48, 172032
    s_waitcnt lgkmcnt(2)
    buffer_store_dwordx4 v[180:183], v245, s[32:35], s49 offen sc0 sc1
    v_mfma_f32_16x16x32_bf16 v[192:195], v[48:51], v[232:235], v[192:195]
    ds_read_b128 v[228:231], v244 offset:25600
    v_mfma_f32_16x16x32_bf16 v[196:199], v[52:55], v[232:235], v[196:199]
    v_mfma_f32_16x16x32_bf16 v[200:203], v[56:59], v[232:235], v[200:203]
    v_mfma_f32_16x16x32_bf16 v[204:207], a[192:195], v[232:235], v[204:207]
    v_mfma_f32_16x16x32_bf16 v[208:211], a[196:199], v[232:235], v[208:211]
    v_mfma_f32_16x16x32_bf16 v[212:215], a[200:203], v[232:235], v[212:215]
    v_mfma_f32_16x16x32_bf16 v[192:195], v[60:63], v[236:239], v[192:195]
    ds_read_b128 v[232:235], v244 offset:26624
    v_mfma_f32_16x16x32_bf16 v[196:199], v[64:67], v[236:239], v[196:199]
    s_waitcnt lgkmcnt(2)
    buffer_store_dwordx4 v[184:187], v246, s[32:35], s49 offen offset:64 sc0 sc1
    v_mfma_f32_16x16x32_bf16 v[200:203], v[68:71], v[236:239], v[200:203]
    v_mfma_f32_16x16x32_bf16 v[204:207], a[204:207], v[236:239], v[204:207]
    v_mfma_f32_16x16x32_bf16 v[208:211], a[208:211], v[236:239], v[208:211]
    v_mfma_f32_16x16x32_bf16 v[212:215], a[212:215], v[236:239], v[212:215]
    v_mfma_f32_16x16x32_bf16 v[204:207], a[216:219], a[252:255], v[204:207]
    ds_read_b128 v[236:239], v244 offset:24592
    v_cvt_pk_bf16_f32 v192, v192, v193
    v_mfma_f32_16x16x32_bf16 v[208:211], a[220:223], a[252:255], v[208:211]
    v_cvt_pk_bf16_f32 v193, v194, v195
    ds_write_b64 v253, v[192:193] offset:16640
    v_mfma_f32_16x16x32_bf16 v[212:215], a[224:227], a[252:255], v[212:215]
    v_cvt_pk_bf16_f32 v194, v196, v197
    v_cvt_pk_bf16_f32 v195, v198, v199
    s_waitcnt lgkmcnt(3)
    v_mfma_f32_16x16x32_bf16 v[204:207], a[228:231], v[228:231], v[204:207]
    ds_read_b128 a[252:255], v244 offset:25616
    ds_write_b64 v253, v[194:195] offset:16672
    v_mfma_f32_16x16x32_bf16 v[208:211], a[232:235], v[228:231], v[208:211]
    v_cvt_pk_bf16_f32 v196, v200, v201
    v_cvt_pk_bf16_f32 v197, v202, v203
    v_mfma_f32_16x16x32_bf16 v[212:215], a[236:239], v[228:231], v[212:215]
    ds_write_b64 v253, v[196:197] offset:16704
    s_waitcnt lgkmcnt(5)
    v_mfma_f32_16x16x32_bf16 v[204:207], a[240:243], v[232:235], v[204:207]
    ds_read_b128 v[228:231], v244 offset:26640
    v_mfma_f32_16x16x32_bf16 v[208:211], a[244:247], v[232:235], v[208:211]
    v_mfma_f32_16x16x32_bf16 v[212:215], a[248:251], v[232:235], v[212:215]
    s_waitcnt lgkmcnt(5)
    v_mfma_f32_16x16x32_bf16 v[204:207], v[0:3], v[236:239], v[204:207]
    ds_read_b128 v[232:235], v244 offset:24608
    v_mfma_f32_16x16x32_bf16 v[208:211], v[4:7], v[236:239], v[208:211]
    v_mfma_f32_16x16x32_bf16 v[212:215], v[8:11], v[236:239], v[212:215]
    s_waitcnt lgkmcnt(4)
    v_mfma_f32_16x16x32_bf16 v[204:207], v[12:15], a[252:255], v[204:207]
    ds_read_b128 v[236:239], v244 offset:25632
    v_mfma_f32_16x16x32_bf16 v[208:211], v[16:19], a[252:255], v[208:211]
    v_mfma_f32_16x16x32_bf16 v[212:215], v[20:23], a[252:255], v[212:215]
    s_waitcnt lgkmcnt(2)
    v_mfma_f32_16x16x32_bf16 v[204:207], v[24:27], v[228:231], v[204:207]
    s_barrier
    ds_read_b128 a[252:255], v244 offset:26656
    v_mfma_f32_16x16x32_bf16 v[208:211], v[28:31], v[228:231], v[208:211]
    ds_read_b128 v[192:195], v254 offset:16640
    ds_read_b128 v[196:199], v255 offset:16640
    s_waitcnt lgkmcnt(4)
    v_mfma_f32_16x16x32_bf16 v[204:207], v[36:39], v[232:235], v[204:207]
    v_mfma_f32_16x16x32_bf16 v[208:211], v[40:43], v[232:235], v[208:211]
    s_waitcnt lgkmcnt(3)
    v_mfma_f32_16x16x32_bf16 v[204:207], v[48:51], v[236:239], v[204:207]
    v_mfma_f32_16x16x32_bf16 v[208:211], v[52:55], v[236:239], v[208:211]
    s_waitcnt lgkmcnt(2)
    v_mfma_f32_16x16x32_bf16 v[204:207], v[60:63], a[252:255], v[204:207]
    v_mfma_f32_16x16x32_bf16 v[208:211], v[64:67], a[252:255], v[208:211]
    s_add_u32 s49, s48, 215040
    s_waitcnt lgkmcnt(1)
    buffer_store_dwordx4 v[192:195], v245, s[32:35], s49 offen sc0 sc1
    v_mfma_f32_16x16x32_bf16 v[212:215], v[32:35], v[228:231], v[212:215]
    s_nop 2
    v_mfma_f32_16x16x32_bf16 v[212:215], v[44:47], v[232:235], v[212:215]
    v_cvt_pk_bf16_f32 v204, v204, v205
    v_cvt_pk_bf16_f32 v205, v206, v207
    v_mfma_f32_16x16x32_bf16 v[212:215], v[56:59], v[236:239], v[212:215]
    ds_write_b64 v253, v[204:205] offset:19968
    v_cvt_pk_bf16_f32 v206, v208, v209
    v_mfma_f32_16x16x32_bf16 v[212:215], v[68:71], a[252:255], v[212:215]
    v_cvt_pk_bf16_f32 v207, v210, v211
    ds_write_b64 v253, v[206:207] offset:20000
    s_nop 5
    v_cvt_pk_bf16_f32 v208, v212, v213
    v_cvt_pk_bf16_f32 v209, v214, v215
    ds_write_b64 v253, v[208:209] offset:20032
    s_waitcnt lgkmcnt(3)
    buffer_store_dwordx4 v[196:199], v246, s[32:35], s49 offen offset:64 sc0 sc1
    s_waitcnt lgkmcnt(0)
    s_barrier
    ds_read_b128 v[204:207], v254 offset:19968
    ds_read_b128 v[208:211], v255 offset:19968
    s_add_u32 s49, s48, 258048
    s_waitcnt lgkmcnt(1)
    buffer_store_dwordx4 v[204:207], v245, s[32:35], s49 offen sc0 sc1
    s_waitcnt lgkmcnt(0)
    buffer_store_dwordx4 v[208:211], v246, s[32:35], s49 offen offset:64 sc0 sc1
L_END:
    s_endpgm
.section .rodata,"a"
.p2align 6
.amdhsa_kernel standalone__detection_seg_fpn_lateral__vision_kernel
  .amdhsa_next_free_vgpr 512
  .amdhsa_next_free_sgpr 102
  .amdhsa_accum_offset 256
  .amdhsa_group_segment_fixed_size 0
  .amdhsa_kernarg_size 56
  .amdhsa_user_sgpr_count 2
  .amdhsa_user_sgpr_kernarg_segment_ptr 1
  .amdhsa_system_sgpr_workgroup_id_x 1
.end_amdhsa_kernel
```
